```python
import torch

def _softmax(x, axis=-1):
    return torch.softmax(x, dim=axis)

def _gelu(x):
    return torch.nn.functional.gelu(x, approximate='tanh')

def _silu(x):
    return torch.nn.functional.silu(x)

def _sigmoid(x):
    return torch.sigmoid(x)

def _layernorm(x, axis=-1, eps=1e-05):
    m = x.mean(dim=axis, keepdim=True)
    v = x.var(dim=axis, keepdim=True, unbiased=False)
    return (x - m) / torch.sqrt(v + eps)

def _scatter_add(tgt, idx, src, axis=0):
    return tgt.clone().index_add_(axis, idx, src)

def _segment_sum(src, seg, n):
    out = torch.zeros((n,) + src.shape[1:], dtype=src.dtype)
    return out.index_add_(0, seg, src)

def _pad(x, pw):
    flat = tuple((v for pair in reversed(pw) for v in pair))
    return torch.nn.functional.pad(x, flat)
kernel_name = 'adaLN_cond__mha_block_cached__mixer_gmlp__prompt'

def setup_inputs():

    _w = lambda a: (lambda t: t.to(torch.bfloat16) if t.is_floating_point() else t)(torch.as_tensor(a))

    def _A_setup():
        B, Sq, D = (1, 2048, 512)
        H, Sk, Dh = (32, 2048, 128)
        return {'x': _w((lambda *s: torch.randn(*s, dtype=torch.bfloat16) * 0.05)(B, Sq, D)), 'k_cache': _w((lambda *s: torch.randn(*s, dtype=torch.bfloat16) * 3.2)(B, H, Sk, Dh)), 'v_cache': _w((lambda *s: torch.randn(*s, dtype=torch.bfloat16) * 0.4)(B, H, Sk, Dh)), 'wq': _w((lambda *s: torch.randn(*s, dtype=torch.bfloat16) * 3.2)(D, H * Dh) * D ** (-0.5)), 'wo': _w((lambda *s: torch.randn(*s, dtype=torch.bfloat16) * 0.4)(H * Dh, D) * (H * Dh) ** (-0.5))}
    _A_in = _A_setup()

    def _B_setup():
        B, S, D, F = (1, 2048, 512, 1792)
        Fh = F // 2
        return {'x': _w((lambda *s: torch.randn(*s, dtype=torch.bfloat16) * 0.05)(B, S, D)), 'w_in': _w((lambda *s: torch.randn(*s, dtype=torch.bfloat16) * 0.8)(D, 2 * Fh)), 'w_sp': _w(0.01 * (lambda *s: torch.randn(*s, dtype=torch.bfloat16) * 0.8)(S, S)), 'b_sp': _w(1.0 + 0.01 * (lambda *s: torch.randn(*s, dtype=torch.bfloat16) * 0.05)(S)), 'w_out': _w((lambda *s: torch.randn(*s, dtype=torch.bfloat16) * 0.05)(Fh, D))}
    _B_in = _B_setup()
    return {'A_x': _A_in['x'], 'A_k_cache': _A_in['k_cache'], 'A_v_cache': _A_in['v_cache'], 'A_wq': _A_in['wq'], 'A_wo': _A_in['wo'], 'B_x': _B_in['x'], 'B_w_in': _B_in['w_in'], 'B_w_sp': _B_in['w_sp'], 'B_b_sp': _B_in['b_sp'], 'B_w_out': _B_in['w_out'], 'c': _w((lambda *s: torch.randn(*s, dtype=torch.bfloat16) * 0.1)(1, 512) * 8.0), 'w_mod': _w((lambda *s: torch.randn(*s, dtype=torch.bfloat16) * 0.1)(512, 6 * 512) * 512 ** (-0.5) * 8.0)}

def reference(A_x, A_k_cache, A_v_cache, A_wq, A_wo, B_x, B_w_in, B_w_sp, B_b_sp, B_w_out, c, w_mod):

    def _A_ref(x, k_cache, v_cache, wq, wo):
        B, Sq, D = x.shape
        H, Dh = (32, 128)
        q = (lambda x, *d: x.permute(*d))((x @ wq).reshape(B, Sq, H, Dh), 0, 2, 1, 3)
        scores = torch.einsum('bhqd,bhkd->bhqk', q, k_cache) * Dh ** (-0.5)
        p = _softmax(scores, axis=-1)
        o = torch.einsum('bhqk,bhkd->bhqd', p, v_cache)
        return (lambda x, *d: x.permute(*d))(o, 0, 2, 1, 3).reshape(B, Sq, H * Dh) @ wo

    def _B_ref(x, w_in, w_sp, b_sp, w_out):
        B, S, D = x.shape
        F = w_in.shape[-1]
        Fh = F // 2
        z = _gelu(torch.einsum('bsd,df->bsf', x, w_in))
        z1 = z[..., :Fh].clone()
        z2 = _layernorm(z[..., Fh:], axis=-1)
        g = torch.einsum('ts,bsf->btf', w_sp, z2) + b_sp[None, :, None]
        return torch.einsum('bsf,fd->bsd', z1 * g, w_out)
    x = A_x
    mod = (_silu(c) @ w_mod).reshape(c.shape[0], 6, 1, -1)
    sa, ca, ga, sb, cb, gb = (mod[:, 0].clone(), mod[:, 1].clone(), mod[:, 2].clone(), mod[:, 3].clone(), mod[:, 4].clone(), mod[:, 5].clone())
    h = _layernorm(x, axis=-1) * (1 + ca) + sa
    x = x + ga * _A_ref(h, A_k_cache, A_v_cache, A_wq, A_wo)
    h = _layernorm(x, axis=-1) * (1 + cb) + sb
    x = x + gb * _B_ref(h, B_w_in, B_w_sp, B_b_sp, B_w_out)
    return x
```

```asm
; @launch kernel=mod_kernel grid=(48,1,1) block=(256,1,1) lds=4096
; @launch kernel=ln1_kernel grid=(512,1,1) block=(256,1,1) lds=0
; @launch kernel=qproj_kernel grid=(512,1,1) block=(256,1,1) lds=65536
; @launch kernel=attn_kernel grid=(512,1,1) block=(256,1,1) lds=65536
; @launch kernel=wo_kernel grid=(256,1,1) block=(256,1,1) lds=98304
; @launch kernel=ln2_kernel grid=(512,1,1) block=(256,1,1) lds=0
; @launch kernel=win_kernel grid=(224,1,1) block=(256,1,1) lds=98304
; @launch kernel=ln3_kernel grid=(512,1,1) block=(256,1,1) lds=0
; @launch kernel=wsp_kernel grid=(224,1,1) block=(256,1,1) lds=73728
; @launch kernel=wout_kernel grid=(256,1,1) block=(256,1,1) lds=81920
.amdgcn_target "amdgcn-amd-amdhsa--gfx950"
.text
.globl mod_kernel
.p2align 8
.type mod_kernel,@function
mod_kernel:
    s_cmp_ge_u32 s2, 48
    s_cbranch_scc1 mod_done
    s_load_dwordx2 s[4:5], s[0:1], 80
    s_load_dwordx2 s[6:7], s[0:1], 88
    s_load_dwordx2 s[8:9], s[0:1], 112
    s_waitcnt lgkmcnt(0)
    s_mov_b32 s12, s4
    s_mov_b32 s13, s5
    s_and_b32 s13, s13, 0xffff
    s_mov_b32 s14, 1024
    s_mov_b32 s15, 0x20000
    s_mov_b32 s16, s6
    s_mov_b32 s17, s7
    s_and_b32 s17, s17, 0xffff
    s_mov_b32 s18, 3145728
    s_mov_b32 s19, 0x20000
    s_mov_b32 s20, s8
    s_mov_b32 s21, s9
    s_and_b32 s21, s21, 0xffff
    s_mov_b32 s22, 12288
    s_mov_b32 s23, 0x20000
    v_lshlrev_b32 v2, 2, v0
    buffer_load_dword v1, v2, s[12:15], 0 offen
    s_waitcnt vmcnt(0)
    v_lshlrev_b32 v4, 16, v1
    v_and_b32 v5, 0xffff0000, v1
    v_mul_f32 v3, 0xbfb8aa3b, v4
    v_exp_f32 v3, v3
    s_nop 0
    v_add_f32 v3, 1.0, v3
    v_rcp_f32 v3, v3
    s_nop 0
    v_mul_f32 v3, v4, v3
    v_cvt_pk_bf16_f32 v3, v3, v3
    v_lshlrev_b32 v4, 16, v3
    v_mul_f32 v3, 0xbfb8aa3b, v5
    v_exp_f32 v3, v3
    s_nop 0
    v_add_f32 v3, 1.0, v3
    v_rcp_f32 v3, v3
    s_nop 0
    v_mul_f32 v3, v5, v3
    v_cvt_pk_bf16_f32 v3, v3, v3
    v_lshlrev_b32 v5, 16, v3
    v_lshlrev_b32 v2, 3, v0
    ds_write_b64 v2, v[4:5]
    s_waitcnt lgkmcnt(0)
    s_barrier
    v_lshrrev_b32 v6, 6, v0
    v_and_b32 v7, 63, v0
    s_lshl_b32 s24, s2, 7
    v_lshlrev_b32 v8, 1, v7
    v_add_u32 v8, s24, v8
    v_mul_u32_u24 v9, 128*6144, v6
    v_add_u32 v8, v8, v9
    v_lshlrev_b32 v9, 9, v6
    v_mov_b32 v10, 0
    s_mov_b32 s25, 0
    buffer_load_ushort v32, v8, s[16:19], s25 offen
    s_add_u32 s25, s25, 6144
    buffer_load_ushort v33, v8, s[16:19], s25 offen
    s_add_u32 s25, s25, 6144
    buffer_load_ushort v34, v8, s[16:19], s25 offen
    s_add_u32 s25, s25, 6144
    buffer_load_ushort v35, v8, s[16:19], s25 offen
    s_add_u32 s25, s25, 6144
    buffer_load_ushort v36, v8, s[16:19], s25 offen
    s_add_u32 s25, s25, 6144
    buffer_load_ushort v37, v8, s[16:19], s25 offen
    s_add_u32 s25, s25, 6144
    buffer_load_ushort v38, v8, s[16:19], s25 offen
    s_add_u32 s25, s25, 6144
    buffer_load_ushort v39, v8, s[16:19], s25 offen
    s_add_u32 s25, s25, 6144
    buffer_load_ushort v40, v8, s[16:19], s25 offen
    s_add_u32 s25, s25, 6144
    buffer_load_ushort v41, v8, s[16:19], s25 offen
    s_add_u32 s25, s25, 6144
    buffer_load_ushort v42, v8, s[16:19], s25 offen
    s_add_u32 s25, s25, 6144
    buffer_load_ushort v43, v8, s[16:19], s25 offen
    s_add_u32 s25, s25, 6144
    buffer_load_ushort v44, v8, s[16:19], s25 offen
    s_add_u32 s25, s25, 6144
    buffer_load_ushort v45, v8, s[16:19], s25 offen
    s_add_u32 s25, s25, 6144
    buffer_load_ushort v46, v8, s[16:19], s25 offen
    s_add_u32 s25, s25, 6144
    buffer_load_ushort v47, v8, s[16:19], s25 offen
    s_add_u32 s25, s25, 6144
    buffer_load_ushort v48, v8, s[16:19], s25 offen
    s_add_u32 s25, s25, 6144
    buffer_load_ushort v49, v8, s[16:19], s25 offen
    s_add_u32 s25, s25, 6144
    buffer_load_ushort v50, v8, s[16:19], s25 offen
    s_add_u32 s25, s25, 6144
    buffer_load_ushort v51, v8, s[16:19], s25 offen
    s_add_u32 s25, s25, 6144
    buffer_load_ushort v52, v8, s[16:19], s25 offen
    s_add_u32 s25, s25, 6144
    buffer_load_ushort v53, v8, s[16:19], s25 offen
    s_add_u32 s25, s25, 6144
    buffer_load_ushort v54, v8, s[16:19], s25 offen
    s_add_u32 s25, s25, 6144
    buffer_load_ushort v55, v8, s[16:19], s25 offen
    s_add_u32 s25, s25, 6144
    buffer_load_ushort v56, v8, s[16:19], s25 offen
    s_add_u32 s25, s25, 6144
    buffer_load_ushort v57, v8, s[16:19], s25 offen
    s_add_u32 s25, s25, 6144
    buffer_load_ushort v58, v8, s[16:19], s25 offen
    s_add_u32 s25, s25, 6144
    buffer_load_ushort v59, v8, s[16:19], s25 offen
    s_add_u32 s25, s25, 6144
    buffer_load_ushort v60, v8, s[16:19], s25 offen
    s_add_u32 s25, s25, 6144
    buffer_load_ushort v61, v8, s[16:19], s25 offen
    s_add_u32 s25, s25, 6144
    buffer_load_ushort v62, v8, s[16:19], s25 offen
    s_add_u32 s25, s25, 6144
    buffer_load_ushort v63, v8, s[16:19], s25 offen
    s_add_u32 s25, s25, 6144
    ds_read_b128 v[64:67], v9 offset:0
    ds_read_b128 v[68:71], v9 offset:16
    ds_read_b128 v[72:75], v9 offset:32
    ds_read_b128 v[76:79], v9 offset:48
    ds_read_b128 v[80:83], v9 offset:64
    ds_read_b128 v[84:87], v9 offset:80
    ds_read_b128 v[88:91], v9 offset:96
    ds_read_b128 v[92:95], v9 offset:112
    s_waitcnt vmcnt(0) lgkmcnt(0)
    v_lshlrev_b32 v32, 16, v32
    v_lshlrev_b32 v33, 16, v33
    v_lshlrev_b32 v34, 16, v34
    v_lshlrev_b32 v35, 16, v35
    v_lshlrev_b32 v36, 16, v36
    v_lshlrev_b32 v37, 16, v37
    v_lshlrev_b32 v38, 16, v38
    v_lshlrev_b32 v39, 16, v39
    v_lshlrev_b32 v40, 16, v40
    v_lshlrev_b32 v41, 16, v41
    v_lshlrev_b32 v42, 16, v42
    v_lshlrev_b32 v43, 16, v43
    v_lshlrev_b32 v44, 16, v44
    v_lshlrev_b32 v45, 16, v45
    v_lshlrev_b32 v46, 16, v46
    v_lshlrev_b32 v47, 16, v47
    v_lshlrev_b32 v48, 16, v48
    v_lshlrev_b32 v49, 16, v49
    v_lshlrev_b32 v50, 16, v50
    v_lshlrev_b32 v51, 16, v51
    v_lshlrev_b32 v52, 16, v52
    v_lshlrev_b32 v53, 16, v53
    v_lshlrev_b32 v54, 16, v54
    v_lshlrev_b32 v55, 16, v55
    v_lshlrev_b32 v56, 16, v56
    v_lshlrev_b32 v57, 16, v57
    v_lshlrev_b32 v58, 16, v58
    v_lshlrev_b32 v59, 16, v59
    v_lshlrev_b32 v60, 16, v60
    v_lshlrev_b32 v61, 16, v61
    v_lshlrev_b32 v62, 16, v62
    v_lshlrev_b32 v63, 16, v63
    v_fmac_f32 v10, v32, v64
    v_fmac_f32 v10, v33, v65
    v_fmac_f32 v10, v34, v66
    v_fmac_f32 v10, v35, v67
    v_fmac_f32 v10, v36, v68
    v_fmac_f32 v10, v37, v69
    v_fmac_f32 v10, v38, v70
    v_fmac_f32 v10, v39, v71
    v_fmac_f32 v10, v40, v72
    v_fmac_f32 v10, v41, v73
    v_fmac_f32 v10, v42, v74
    v_fmac_f32 v10, v43, v75
    v_fmac_f32 v10, v44, v76
    v_fmac_f32 v10, v45, v77
    v_fmac_f32 v10, v46, v78
    v_fmac_f32 v10, v47, v79
    v_fmac_f32 v10, v48, v80
    v_fmac_f32 v10, v49, v81
    v_fmac_f32 v10, v50, v82
    v_fmac_f32 v10, v51, v83
    v_fmac_f32 v10, v52, v84
    v_fmac_f32 v10, v53, v85
    v_fmac_f32 v10, v54, v86
    v_fmac_f32 v10, v55, v87
    v_fmac_f32 v10, v56, v88
    v_fmac_f32 v10, v57, v89
    v_fmac_f32 v10, v58, v90
    v_fmac_f32 v10, v59, v91
    v_fmac_f32 v10, v60, v92
    v_fmac_f32 v10, v61, v93
    v_fmac_f32 v10, v62, v94
    v_fmac_f32 v10, v63, v95
    buffer_load_ushort v32, v8, s[16:19], s25 offen
    s_add_u32 s25, s25, 6144
    buffer_load_ushort v33, v8, s[16:19], s25 offen
    s_add_u32 s25, s25, 6144
    buffer_load_ushort v34, v8, s[16:19], s25 offen
    s_add_u32 s25, s25, 6144
    buffer_load_ushort v35, v8, s[16:19], s25 offen
    s_add_u32 s25, s25, 6144
    buffer_load_ushort v36, v8, s[16:19], s25 offen
    s_add_u32 s25, s25, 6144
    buffer_load_ushort v37, v8, s[16:19], s25 offen
    s_add_u32 s25, s25, 6144
    buffer_load_ushort v38, v8, s[16:19], s25 offen
    s_add_u32 s25, s25, 6144
    buffer_load_ushort v39, v8, s[16:19], s25 offen
    s_add_u32 s25, s25, 6144
    buffer_load_ushort v40, v8, s[16:19], s25 offen
    s_add_u32 s25, s25, 6144
    buffer_load_ushort v41, v8, s[16:19], s25 offen
    s_add_u32 s25, s25, 6144
    buffer_load_ushort v42, v8, s[16:19], s25 offen
    s_add_u32 s25, s25, 6144
    buffer_load_ushort v43, v8, s[16:19], s25 offen
    s_add_u32 s25, s25, 6144
    buffer_load_ushort v44, v8, s[16:19], s25 offen
    s_add_u32 s25, s25, 6144
    buffer_load_ushort v45, v8, s[16:19], s25 offen
    s_add_u32 s25, s25, 6144
    buffer_load_ushort v46, v8, s[16:19], s25 offen
    s_add_u32 s25, s25, 6144
    buffer_load_ushort v47, v8, s[16:19], s25 offen
    s_add_u32 s25, s25, 6144
    buffer_load_ushort v48, v8, s[16:19], s25 offen
    s_add_u32 s25, s25, 6144
    buffer_load_ushort v49, v8, s[16:19], s25 offen
    s_add_u32 s25, s25, 6144
    buffer_load_ushort v50, v8, s[16:19], s25 offen
    s_add_u32 s25, s25, 6144
    buffer_load_ushort v51, v8, s[16:19], s25 offen
    s_add_u32 s25, s25, 6144
    buffer_load_ushort v52, v8, s[16:19], s25 offen
    s_add_u32 s25, s25, 6144
    buffer_load_ushort v53, v8, s[16:19], s25 offen
    s_add_u32 s25, s25, 6144
    buffer_load_ushort v54, v8, s[16:19], s25 offen
    s_add_u32 s25, s25, 6144
    buffer_load_ushort v55, v8, s[16:19], s25 offen
    s_add_u32 s25, s25, 6144
    buffer_load_ushort v56, v8, s[16:19], s25 offen
    s_add_u32 s25, s25, 6144
    buffer_load_ushort v57, v8, s[16:19], s25 offen
    s_add_u32 s25, s25, 6144
    buffer_load_ushort v58, v8, s[16:19], s25 offen
    s_add_u32 s25, s25, 6144
    buffer_load_ushort v59, v8, s[16:19], s25 offen
    s_add_u32 s25, s25, 6144
    buffer_load_ushort v60, v8, s[16:19], s25 offen
    s_add_u32 s25, s25, 6144
    buffer_load_ushort v61, v8, s[16:19], s25 offen
    s_add_u32 s25, s25, 6144
    buffer_load_ushort v62, v8, s[16:19], s25 offen
    s_add_u32 s25, s25, 6144
    buffer_load_ushort v63, v8, s[16:19], s25 offen
    s_add_u32 s25, s25, 6144
    ds_read_b128 v[64:67], v9 offset:128
    ds_read_b128 v[68:71], v9 offset:144
    ds_read_b128 v[72:75], v9 offset:160
    ds_read_b128 v[76:79], v9 offset:176
    ds_read_b128 v[80:83], v9 offset:192
    ds_read_b128 v[84:87], v9 offset:208
    ds_read_b128 v[88:91], v9 offset:224
    ds_read_b128 v[92:95], v9 offset:240
    s_waitcnt vmcnt(0) lgkmcnt(0)
    v_lshlrev_b32 v32, 16, v32
    v_lshlrev_b32 v33, 16, v33
    v_lshlrev_b32 v34, 16, v34
    v_lshlrev_b32 v35, 16, v35
    v_lshlrev_b32 v36, 16, v36
    v_lshlrev_b32 v37, 16, v37
    v_lshlrev_b32 v38, 16, v38
    v_lshlrev_b32 v39, 16, v39
    v_lshlrev_b32 v40, 16, v40
    v_lshlrev_b32 v41, 16, v41
    v_lshlrev_b32 v42, 16, v42
    v_lshlrev_b32 v43, 16, v43
    v_lshlrev_b32 v44, 16, v44
    v_lshlrev_b32 v45, 16, v45
    v_lshlrev_b32 v46, 16, v46
    v_lshlrev_b32 v47, 16, v47
    v_lshlrev_b32 v48, 16, v48
    v_lshlrev_b32 v49, 16, v49
    v_lshlrev_b32 v50, 16, v50
    v_lshlrev_b32 v51, 16, v51
    v_lshlrev_b32 v52, 16, v52
    v_lshlrev_b32 v53, 16, v53
    v_lshlrev_b32 v54, 16, v54
    v_lshlrev_b32 v55, 16, v55
    v_lshlrev_b32 v56, 16, v56
    v_lshlrev_b32 v57, 16, v57
    v_lshlrev_b32 v58, 16, v58
    v_lshlrev_b32 v59, 16, v59
    v_lshlrev_b32 v60, 16, v60
    v_lshlrev_b32 v61, 16, v61
    v_lshlrev_b32 v62, 16, v62
    v_lshlrev_b32 v63, 16, v63
    v_fmac_f32 v10, v32, v64
    v_fmac_f32 v10, v33, v65
    v_fmac_f32 v10, v34, v66
    v_fmac_f32 v10, v35, v67
    v_fmac_f32 v10, v36, v68
    v_fmac_f32 v10, v37, v69
    v_fmac_f32 v10, v38, v70
    v_fmac_f32 v10, v39, v71
    v_fmac_f32 v10, v40, v72
    v_fmac_f32 v10, v41, v73
    v_fmac_f32 v10, v42, v74
    v_fmac_f32 v10, v43, v75
    v_fmac_f32 v10, v44, v76
    v_fmac_f32 v10, v45, v77
    v_fmac_f32 v10, v46, v78
    v_fmac_f32 v10, v47, v79
    v_fmac_f32 v10, v48, v80
    v_fmac_f32 v10, v49, v81
    v_fmac_f32 v10, v50, v82
    v_fmac_f32 v10, v51, v83
    v_fmac_f32 v10, v52, v84
    v_fmac_f32 v10, v53, v85
    v_fmac_f32 v10, v54, v86
    v_fmac_f32 v10, v55, v87
    v_fmac_f32 v10, v56, v88
    v_fmac_f32 v10, v57, v89
    v_fmac_f32 v10, v58, v90
    v_fmac_f32 v10, v59, v91
    v_fmac_f32 v10, v60, v92
    v_fmac_f32 v10, v61, v93
    v_fmac_f32 v10, v62, v94
    v_fmac_f32 v10, v63, v95
    buffer_load_ushort v32, v8, s[16:19], s25 offen
    s_add_u32 s25, s25, 6144
    buffer_load_ushort v33, v8, s[16:19], s25 offen
    s_add_u32 s25, s25, 6144
    buffer_load_ushort v34, v8, s[16:19], s25 offen
    s_add_u32 s25, s25, 6144
    buffer_load_ushort v35, v8, s[16:19], s25 offen
    s_add_u32 s25, s25, 6144
    buffer_load_ushort v36, v8, s[16:19], s25 offen
    s_add_u32 s25, s25, 6144
    buffer_load_ushort v37, v8, s[16:19], s25 offen
    s_add_u32 s25, s25, 6144
    buffer_load_ushort v38, v8, s[16:19], s25 offen
    s_add_u32 s25, s25, 6144
    buffer_load_ushort v39, v8, s[16:19], s25 offen
    s_add_u32 s25, s25, 6144
    buffer_load_ushort v40, v8, s[16:19], s25 offen
    s_add_u32 s25, s25, 6144
    buffer_load_ushort v41, v8, s[16:19], s25 offen
    s_add_u32 s25, s25, 6144
    buffer_load_ushort v42, v8, s[16:19], s25 offen
    s_add_u32 s25, s25, 6144
    buffer_load_ushort v43, v8, s[16:19], s25 offen
    s_add_u32 s25, s25, 6144
    buffer_load_ushort v44, v8, s[16:19], s25 offen
    s_add_u32 s25, s25, 6144
    buffer_load_ushort v45, v8, s[16:19], s25 offen
    s_add_u32 s25, s25, 6144
    buffer_load_ushort v46, v8, s[16:19], s25 offen
    s_add_u32 s25, s25, 6144
    buffer_load_ushort v47, v8, s[16:19], s25 offen
    s_add_u32 s25, s25, 6144
    buffer_load_ushort v48, v8, s[16:19], s25 offen
    s_add_u32 s25, s25, 6144
    buffer_load_ushort v49, v8, s[16:19], s25 offen
    s_add_u32 s25, s25, 6144
    buffer_load_ushort v50, v8, s[16:19], s25 offen
    s_add_u32 s25, s25, 6144
    buffer_load_ushort v51, v8, s[16:19], s25 offen
    s_add_u32 s25, s25, 6144
    buffer_load_ushort v52, v8, s[16:19], s25 offen
    s_add_u32 s25, s25, 6144
    buffer_load_ushort v53, v8, s[16:19], s25 offen
    s_add_u32 s25, s25, 6144
    buffer_load_ushort v54, v8, s[16:19], s25 offen
    s_add_u32 s25, s25, 6144
    buffer_load_ushort v55, v8, s[16:19], s25 offen
    s_add_u32 s25, s25, 6144
    buffer_load_ushort v56, v8, s[16:19], s25 offen
    s_add_u32 s25, s25, 6144
    buffer_load_ushort v57, v8, s[16:19], s25 offen
    s_add_u32 s25, s25, 6144
    buffer_load_ushort v58, v8, s[16:19], s25 offen
    s_add_u32 s25, s25, 6144
    buffer_load_ushort v59, v8, s[16:19], s25 offen
    s_add_u32 s25, s25, 6144
    buffer_load_ushort v60, v8, s[16:19], s25 offen
    s_add_u32 s25, s25, 6144
    buffer_load_ushort v61, v8, s[16:19], s25 offen
    s_add_u32 s25, s25, 6144
    buffer_load_ushort v62, v8, s[16:19], s25 offen
    s_add_u32 s25, s25, 6144
    buffer_load_ushort v63, v8, s[16:19], s25 offen
    s_add_u32 s25, s25, 6144
    ds_read_b128 v[64:67], v9 offset:256
    ds_read_b128 v[68:71], v9 offset:272
    ds_read_b128 v[72:75], v9 offset:288
    ds_read_b128 v[76:79], v9 offset:304
    ds_read_b128 v[80:83], v9 offset:320
    ds_read_b128 v[84:87], v9 offset:336
    ds_read_b128 v[88:91], v9 offset:352
    ds_read_b128 v[92:95], v9 offset:368
    s_waitcnt vmcnt(0) lgkmcnt(0)
    v_lshlrev_b32 v32, 16, v32
    v_lshlrev_b32 v33, 16, v33
    v_lshlrev_b32 v34, 16, v34
    v_lshlrev_b32 v35, 16, v35
    v_lshlrev_b32 v36, 16, v36
    v_lshlrev_b32 v37, 16, v37
    v_lshlrev_b32 v38, 16, v38
    v_lshlrev_b32 v39, 16, v39
    v_lshlrev_b32 v40, 16, v40
    v_lshlrev_b32 v41, 16, v41
    v_lshlrev_b32 v42, 16, v42
    v_lshlrev_b32 v43, 16, v43
    v_lshlrev_b32 v44, 16, v44
    v_lshlrev_b32 v45, 16, v45
    v_lshlrev_b32 v46, 16, v46
    v_lshlrev_b32 v47, 16, v47
    v_lshlrev_b32 v48, 16, v48
    v_lshlrev_b32 v49, 16, v49
    v_lshlrev_b32 v50, 16, v50
    v_lshlrev_b32 v51, 16, v51
    v_lshlrev_b32 v52, 16, v52
    v_lshlrev_b32 v53, 16, v53
    v_lshlrev_b32 v54, 16, v54
    v_lshlrev_b32 v55, 16, v55
    v_lshlrev_b32 v56, 16, v56
    v_lshlrev_b32 v57, 16, v57
    v_lshlrev_b32 v58, 16, v58
    v_lshlrev_b32 v59, 16, v59
    v_lshlrev_b32 v60, 16, v60
    v_lshlrev_b32 v61, 16, v61
    v_lshlrev_b32 v62, 16, v62
    v_lshlrev_b32 v63, 16, v63
    v_fmac_f32 v10, v32, v64
    v_fmac_f32 v10, v33, v65
    v_fmac_f32 v10, v34, v66
    v_fmac_f32 v10, v35, v67
    v_fmac_f32 v10, v36, v68
    v_fmac_f32 v10, v37, v69
    v_fmac_f32 v10, v38, v70
    v_fmac_f32 v10, v39, v71
    v_fmac_f32 v10, v40, v72
    v_fmac_f32 v10, v41, v73
    v_fmac_f32 v10, v42, v74
    v_fmac_f32 v10, v43, v75
    v_fmac_f32 v10, v44, v76
    v_fmac_f32 v10, v45, v77
    v_fmac_f32 v10, v46, v78
    v_fmac_f32 v10, v47, v79
    v_fmac_f32 v10, v48, v80
    v_fmac_f32 v10, v49, v81
    v_fmac_f32 v10, v50, v82
    v_fmac_f32 v10, v51, v83
    v_fmac_f32 v10, v52, v84
    v_fmac_f32 v10, v53, v85
    v_fmac_f32 v10, v54, v86
    v_fmac_f32 v10, v55, v87
    v_fmac_f32 v10, v56, v88
    v_fmac_f32 v10, v57, v89
    v_fmac_f32 v10, v58, v90
    v_fmac_f32 v10, v59, v91
    v_fmac_f32 v10, v60, v92
    v_fmac_f32 v10, v61, v93
    v_fmac_f32 v10, v62, v94
    v_fmac_f32 v10, v63, v95
    buffer_load_ushort v32, v8, s[16:19], s25 offen
    s_add_u32 s25, s25, 6144
    buffer_load_ushort v33, v8, s[16:19], s25 offen
    s_add_u32 s25, s25, 6144
    buffer_load_ushort v34, v8, s[16:19], s25 offen
    s_add_u32 s25, s25, 6144
    buffer_load_ushort v35, v8, s[16:19], s25 offen
    s_add_u32 s25, s25, 6144
    buffer_load_ushort v36, v8, s[16:19], s25 offen
    s_add_u32 s25, s25, 6144
    buffer_load_ushort v37, v8, s[16:19], s25 offen
    s_add_u32 s25, s25, 6144
    buffer_load_ushort v38, v8, s[16:19], s25 offen
    s_add_u32 s25, s25, 6144
    buffer_load_ushort v39, v8, s[16:19], s25 offen
    s_add_u32 s25, s25, 6144
    buffer_load_ushort v40, v8, s[16:19], s25 offen
    s_add_u32 s25, s25, 6144
    buffer_load_ushort v41, v8, s[16:19], s25 offen
    s_add_u32 s25, s25, 6144
    buffer_load_ushort v42, v8, s[16:19], s25 offen
    s_add_u32 s25, s25, 6144
    buffer_load_ushort v43, v8, s[16:19], s25 offen
    s_add_u32 s25, s25, 6144
    buffer_load_ushort v44, v8, s[16:19], s25 offen
    s_add_u32 s25, s25, 6144
    buffer_load_ushort v45, v8, s[16:19], s25 offen
    s_add_u32 s25, s25, 6144
    buffer_load_ushort v46, v8, s[16:19], s25 offen
    s_add_u32 s25, s25, 6144
    buffer_load_ushort v47, v8, s[16:19], s25 offen
    s_add_u32 s25, s25, 6144
    buffer_load_ushort v48, v8, s[16:19], s25 offen
    s_add_u32 s25, s25, 6144
    buffer_load_ushort v49, v8, s[16:19], s25 offen
    s_add_u32 s25, s25, 6144
    buffer_load_ushort v50, v8, s[16:19], s25 offen
    s_add_u32 s25, s25, 6144
    buffer_load_ushort v51, v8, s[16:19], s25 offen
    s_add_u32 s25, s25, 6144
    buffer_load_ushort v52, v8, s[16:19], s25 offen
    s_add_u32 s25, s25, 6144
    buffer_load_ushort v53, v8, s[16:19], s25 offen
    s_add_u32 s25, s25, 6144
    buffer_load_ushort v54, v8, s[16:19], s25 offen
    s_add_u32 s25, s25, 6144
    buffer_load_ushort v55, v8, s[16:19], s25 offen
    s_add_u32 s25, s25, 6144
    buffer_load_ushort v56, v8, s[16:19], s25 offen
    s_add_u32 s25, s25, 6144
    buffer_load_ushort v57, v8, s[16:19], s25 offen
    s_add_u32 s25, s25, 6144
    buffer_load_ushort v58, v8, s[16:19], s25 offen
    s_add_u32 s25, s25, 6144
    buffer_load_ushort v59, v8, s[16:19], s25 offen
    s_add_u32 s25, s25, 6144
    buffer_load_ushort v60, v8, s[16:19], s25 offen
    s_add_u32 s25, s25, 6144
    buffer_load_ushort v61, v8, s[16:19], s25 offen
    s_add_u32 s25, s25, 6144
    buffer_load_ushort v62, v8, s[16:19], s25 offen
    s_add_u32 s25, s25, 6144
    buffer_load_ushort v63, v8, s[16:19], s25 offen
    s_add_u32 s25, s25, 6144
    ds_read_b128 v[64:67], v9 offset:384
    ds_read_b128 v[68:71], v9 offset:400
    ds_read_b128 v[72:75], v9 offset:416
    ds_read_b128 v[76:79], v9 offset:432
    ds_read_b128 v[80:83], v9 offset:448
    ds_read_b128 v[84:87], v9 offset:464
    ds_read_b128 v[88:91], v9 offset:480
    ds_read_b128 v[92:95], v9 offset:496
    s_waitcnt vmcnt(0) lgkmcnt(0)
    v_lshlrev_b32 v32, 16, v32
    v_lshlrev_b32 v33, 16, v33
    v_lshlrev_b32 v34, 16, v34
    v_lshlrev_b32 v35, 16, v35
    v_lshlrev_b32 v36, 16, v36
    v_lshlrev_b32 v37, 16, v37
    v_lshlrev_b32 v38, 16, v38
    v_lshlrev_b32 v39, 16, v39
    v_lshlrev_b32 v40, 16, v40
    v_lshlrev_b32 v41, 16, v41
    v_lshlrev_b32 v42, 16, v42
    v_lshlrev_b32 v43, 16, v43
    v_lshlrev_b32 v44, 16, v44
    v_lshlrev_b32 v45, 16, v45
    v_lshlrev_b32 v46, 16, v46
    v_lshlrev_b32 v47, 16, v47
    v_lshlrev_b32 v48, 16, v48
    v_lshlrev_b32 v49, 16, v49
    v_lshlrev_b32 v50, 16, v50
    v_lshlrev_b32 v51, 16, v51
    v_lshlrev_b32 v52, 16, v52
    v_lshlrev_b32 v53, 16, v53
    v_lshlrev_b32 v54, 16, v54
    v_lshlrev_b32 v55, 16, v55
    v_lshlrev_b32 v56, 16, v56
    v_lshlrev_b32 v57, 16, v57
    v_lshlrev_b32 v58, 16, v58
    v_lshlrev_b32 v59, 16, v59
    v_lshlrev_b32 v60, 16, v60
    v_lshlrev_b32 v61, 16, v61
    v_lshlrev_b32 v62, 16, v62
    v_lshlrev_b32 v63, 16, v63
    v_fmac_f32 v10, v32, v64
    v_fmac_f32 v10, v33, v65
    v_fmac_f32 v10, v34, v66
    v_fmac_f32 v10, v35, v67
    v_fmac_f32 v10, v36, v68
    v_fmac_f32 v10, v37, v69
    v_fmac_f32 v10, v38, v70
    v_fmac_f32 v10, v39, v71
    v_fmac_f32 v10, v40, v72
    v_fmac_f32 v10, v41, v73
    v_fmac_f32 v10, v42, v74
    v_fmac_f32 v10, v43, v75
    v_fmac_f32 v10, v44, v76
    v_fmac_f32 v10, v45, v77
    v_fmac_f32 v10, v46, v78
    v_fmac_f32 v10, v47, v79
    v_fmac_f32 v10, v48, v80
    v_fmac_f32 v10, v49, v81
    v_fmac_f32 v10, v50, v82
    v_fmac_f32 v10, v51, v83
    v_fmac_f32 v10, v52, v84
    v_fmac_f32 v10, v53, v85
    v_fmac_f32 v10, v54, v86
    v_fmac_f32 v10, v55, v87
    v_fmac_f32 v10, v56, v88
    v_fmac_f32 v10, v57, v89
    v_fmac_f32 v10, v58, v90
    v_fmac_f32 v10, v59, v91
    v_fmac_f32 v10, v60, v92
    v_fmac_f32 v10, v61, v93
    v_fmac_f32 v10, v62, v94
    v_fmac_f32 v10, v63, v95
    v_lshlrev_b32 v11, 2, v0
    ds_write_b32 v11, v10 offset:2048
    s_waitcnt lgkmcnt(0)
    s_barrier
    v_readfirstlane_b32 s26, v6
    s_nop 3
    s_cmp_lg_u32 s26, 0
    s_cbranch_scc1 mod_done
    v_lshlrev_b32 v11, 2, v7
    ds_read_b32 v12, v11 offset:2048
    ds_read_b32 v13, v11 offset:2304
    ds_read_b32 v14, v11 offset:2560
    ds_read_b32 v15, v11 offset:2816
    s_waitcnt lgkmcnt(0)
    v_add_f32 v12, v12, v13
    v_add_f32 v14, v14, v15
    v_add_f32 v12, v12, v14
    v_cvt_pk_bf16_f32 v12, v12, v12
    v_lshlrev_b32 v12, 16, v12
    s_lshl_b32 s24, s2, 8
    v_add_u32 v11, s24, v11
    buffer_store_dword v12, v11, s[20:23], 0 offen
mod_done:
    s_endpgm
.globl ln1_kernel
.p2align 8
.type ln1_kernel,@function
ln1_kernel:
    s_cmp_ge_u32 s2, 512
    s_cbranch_scc1 ln1_done1
    s_load_dwordx2 s[8:9], s[0:1], 112
    s_load_dwordx2 s[4:5], s[0:1], 0
    s_waitcnt lgkmcnt(0)
    s_mov_b32 s12, s4
    s_mov_b32 s13, s5
    s_and_b32 s13, s13, 0xffff
    s_mov_b32 s14, 2097152
    s_mov_b32 s15, 0x20000
    s_add_u32 s16, s8, 1048576
    s_addc_u32 s17, s9, 0
    s_and_b32 s17, s17, 0xffff
    s_mov_b32 s18, 2097152
    s_mov_b32 s19, 0x20000
    s_mov_b32 s20, s8
    s_mov_b32 s21, s9
    s_and_b32 s21, s21, 0xffff
    s_mov_b32 s22, 12288
    s_mov_b32 s23, 0x20000
    v_lshrrev_b32 v1, 6, v0
    v_and_b32 v2, 63, v0
    s_lshl_b32 s24, s2, 2
    v_add_u32 v1, s24, v1
    v_mul_u32_u24 v3, 1024, v1
    v_lshlrev_b32 v4, 2, v2
    v_add_u32 v3, v3, v4
    v_mul_u32_u24 v5, 1024, v1
    v_add_u32 v5, v5, v4
    buffer_load_dword v10, v3, s[12:15], 0 offen offset:0
    buffer_load_dword v11, v3, s[12:15], 0 offen offset:256
    buffer_load_dword v12, v3, s[12:15], 0 offen offset:512
    buffer_load_dword v13, v3, s[12:15], 0 offen offset:768
    v_lshlrev_b32 v6, 3, v2
    s_mov_b32 s25, 2048
    s_mov_b32 s26, 0
    buffer_load_dwordx2 v[60:61], v6, s[20:23], s25 offen offset:0
    buffer_load_dwordx2 v[76:77], v6, s[20:23], s26 offen offset:0
    buffer_load_dwordx2 v[62:63], v6, s[20:23], s25 offen offset:512
    buffer_load_dwordx2 v[78:79], v6, s[20:23], s26 offen offset:512
    buffer_load_dwordx2 v[64:65], v6, s[20:23], s25 offen offset:1024
    buffer_load_dwordx2 v[80:81], v6, s[20:23], s26 offen offset:1024
    buffer_load_dwordx2 v[66:67], v6, s[20:23], s25 offen offset:1536
    buffer_load_dwordx2 v[82:83], v6, s[20:23], s26 offen offset:1536
    v_xor_b32 v50, 1, v2
    v_lshlrev_b32 v50, 2, v50
    v_xor_b32 v51, 2, v2
    v_lshlrev_b32 v51, 2, v51
    v_xor_b32 v52, 4, v2
    v_lshlrev_b32 v52, 2, v52
    v_xor_b32 v53, 8, v2
    v_lshlrev_b32 v53, 2, v53
    v_xor_b32 v54, 16, v2
    v_lshlrev_b32 v54, 2, v54
    v_xor_b32 v55, 32, v2
    v_lshlrev_b32 v55, 2, v55
    s_waitcnt vmcnt(8)
    v_lshlrev_b32 v20, 16, v10
    v_and_b32 v21, 0xffff0000, v10
    v_lshlrev_b32 v22, 16, v11
    v_and_b32 v23, 0xffff0000, v11
    v_lshlrev_b32 v24, 16, v12
    v_and_b32 v25, 0xffff0000, v12
    v_lshlrev_b32 v26, 16, v13
    v_and_b32 v27, 0xffff0000, v13
    v_add_f32 v7, v20, v21
    v_add_f32 v7, v7, v22
    v_add_f32 v7, v7, v23
    v_add_f32 v7, v7, v24
    v_add_f32 v7, v7, v25
    v_add_f32 v7, v7, v26
    v_add_f32 v7, v7, v27
    ds_bpermute_b32 v8, v50, v7
    s_waitcnt lgkmcnt(0)
    v_add_f32 v7, v7, v8
    ds_bpermute_b32 v8, v51, v7
    s_waitcnt lgkmcnt(0)
    v_add_f32 v7, v7, v8
    ds_bpermute_b32 v8, v52, v7
    s_waitcnt lgkmcnt(0)
    v_add_f32 v7, v7, v8
    ds_bpermute_b32 v8, v53, v7
    s_waitcnt lgkmcnt(0)
    v_add_f32 v7, v7, v8
    ds_bpermute_b32 v8, v54, v7
    s_waitcnt lgkmcnt(0)
    v_add_f32 v7, v7, v8
    ds_bpermute_b32 v8, v55, v7
    s_waitcnt lgkmcnt(0)
    v_add_f32 v7, v7, v8
    v_mul_f32 v7, 0.001953125, v7
    v_sub_f32 v20, v20, v7
    v_sub_f32 v21, v21, v7
    v_sub_f32 v22, v22, v7
    v_sub_f32 v23, v23, v7
    v_sub_f32 v24, v24, v7
    v_sub_f32 v25, v25, v7
    v_sub_f32 v26, v26, v7
    v_sub_f32 v27, v27, v7
    v_mul_f32 v9, v20, v20
    v_fmac_f32 v9, v21, v21
    v_fmac_f32 v9, v22, v22
    v_fmac_f32 v9, v23, v23
    v_fmac_f32 v9, v24, v24
    v_fmac_f32 v9, v25, v25
    v_fmac_f32 v9, v26, v26
    v_fmac_f32 v9, v27, v27
    ds_bpermute_b32 v8, v50, v9
    s_waitcnt lgkmcnt(0)
    v_add_f32 v9, v9, v8
    ds_bpermute_b32 v8, v51, v9
    s_waitcnt lgkmcnt(0)
    v_add_f32 v9, v9, v8
    ds_bpermute_b32 v8, v52, v9
    s_waitcnt lgkmcnt(0)
    v_add_f32 v9, v9, v8
    ds_bpermute_b32 v8, v53, v9
    s_waitcnt lgkmcnt(0)
    v_add_f32 v9, v9, v8
    ds_bpermute_b32 v8, v54, v9
    s_waitcnt lgkmcnt(0)
    v_add_f32 v9, v9, v8
    ds_bpermute_b32 v8, v55, v9
    s_waitcnt lgkmcnt(0)
    v_add_f32 v9, v9, v8
    v_mul_f32 v9, 0.001953125, v9
    v_add_f32 v9, 0x3727c5ac, v9
    v_rsq_f32 v9, v9
    s_nop 0
    s_waitcnt vmcnt(0)
    v_mul_f32 v20, v20, v9
    v_mul_f32 v21, v21, v9
    v_cvt_pk_bf16_f32 v20, v20, v21
    v_and_b32 v21, 0xffff0000, v20
    v_lshlrev_b32 v20, 16, v20
    v_add_f32 v60, 1.0, v60
    v_add_f32 v61, 1.0, v61
    v_cvt_pk_bf16_f32 v60, v60, v61
    v_and_b32 v61, 0xffff0000, v60
    v_lshlrev_b32 v60, 16, v60
    v_mul_f32 v20, v20, v60
    v_mul_f32 v21, v21, v61
    v_cvt_pk_bf16_f32 v20, v20, v21
    v_and_b32 v21, 0xffff0000, v20
    v_lshlrev_b32 v20, 16, v20
    v_add_f32 v20, v20, v76
    v_add_f32 v21, v21, v77
    v_cvt_pk_bf16_f32 v20, v20, v21
    buffer_store_dword v20, v5, s[16:19], 0 offen offset:0
    v_mul_f32 v22, v22, v9
    v_mul_f32 v23, v23, v9
    v_cvt_pk_bf16_f32 v22, v22, v23
    v_and_b32 v23, 0xffff0000, v22
    v_lshlrev_b32 v22, 16, v22
    v_add_f32 v62, 1.0, v62
    v_add_f32 v63, 1.0, v63
    v_cvt_pk_bf16_f32 v62, v62, v63
    v_and_b32 v63, 0xffff0000, v62
    v_lshlrev_b32 v62, 16, v62
    v_mul_f32 v22, v22, v62
    v_mul_f32 v23, v23, v63
    v_cvt_pk_bf16_f32 v22, v22, v23
    v_and_b32 v23, 0xffff0000, v22
    v_lshlrev_b32 v22, 16, v22
    v_add_f32 v22, v22, v78
    v_add_f32 v23, v23, v79
    v_cvt_pk_bf16_f32 v22, v22, v23
    buffer_store_dword v22, v5, s[16:19], 0 offen offset:256
    v_mul_f32 v24, v24, v9
    v_mul_f32 v25, v25, v9
    v_cvt_pk_bf16_f32 v24, v24, v25
    v_and_b32 v25, 0xffff0000, v24
    v_lshlrev_b32 v24, 16, v24
    v_add_f32 v64, 1.0, v64
    v_add_f32 v65, 1.0, v65
    v_cvt_pk_bf16_f32 v64, v64, v65
    v_and_b32 v65, 0xffff0000, v64
    v_lshlrev_b32 v64, 16, v64
    v_mul_f32 v24, v24, v64
    v_mul_f32 v25, v25, v65
    v_cvt_pk_bf16_f32 v24, v24, v25
    v_and_b32 v25, 0xffff0000, v24
    v_lshlrev_b32 v24, 16, v24
    v_add_f32 v24, v24, v80
    v_add_f32 v25, v25, v81
    v_cvt_pk_bf16_f32 v24, v24, v25
    buffer_store_dword v24, v5, s[16:19], 0 offen offset:512
    v_mul_f32 v26, v26, v9
    v_mul_f32 v27, v27, v9
    v_cvt_pk_bf16_f32 v26, v26, v27
    v_and_b32 v27, 0xffff0000, v26
    v_lshlrev_b32 v26, 16, v26
    v_add_f32 v66, 1.0, v66
    v_add_f32 v67, 1.0, v67
    v_cvt_pk_bf16_f32 v66, v66, v67
    v_and_b32 v67, 0xffff0000, v66
    v_lshlrev_b32 v66, 16, v66
    v_mul_f32 v26, v26, v66
    v_mul_f32 v27, v27, v67
    v_cvt_pk_bf16_f32 v26, v26, v27
    v_and_b32 v27, 0xffff0000, v26
    v_lshlrev_b32 v26, 16, v26
    v_add_f32 v26, v26, v82
    v_add_f32 v27, v27, v83
    v_cvt_pk_bf16_f32 v26, v26, v27
    buffer_store_dword v26, v5, s[16:19], 0 offen offset:768
ln1_done1:
    s_endpgm
.globl qproj_kernel
.p2align 8
.type qproj_kernel,@function
qproj_kernel:
    s_cmp_ge_u32 s2, 512
    s_cbranch_scc1 qproj_done1
    s_load_dwordx2 s[28:29], s[0:1], 112
    s_load_dwordx2 s[40:41], s[0:1], 24
    s_waitcnt lgkmcnt(0)
    s_add_u32 s8, s28, 1048576
    s_addc_u32 s9, s29, 0
    s_and_b32 s9, s9, 0xffff
    s_mov_b32 s10, 2097152
    s_mov_b32 s11, 0x20000
    s_mov_b32 s12, s40
    s_mov_b32 s13, s41
    s_and_b32 s13, s13, 0xffff
    s_mov_b32 s14, 4194304
    s_mov_b32 s15, 0x20000
    s_add_u32 s16, s28, 16777216
    s_addc_u32 s17, s29, 0
    s_and_b32 s17, s17, 0xffff
    s_mov_b32 s18, 16777216
    s_mov_b32 s19, 0x20000
    s_and_b32 s39, s2, 0
    s_lshr_b32 s2, s2, 0
    s_mov_b32 s30, 134217729
    s_mul_hi_u32 s31, s2, s30
    s_mul_i32 s32, s31, 32
    s_sub_u32 s32, s2, s32
    s_mul_i32 s33, s31, 128
    s_mul_i32 s34, s32, 128
    v_lshrrev_b32 v1, 6, v0
    v_and_b32 v2, 63, v0
    v_readfirstlane_b32 s35, v1
    s_nop 3
    v_lshrrev_b32 v6, 3, v2
    s_mul_i32 s36, s35, 32
    s_add_u32 s36, s36, s33
    v_add_u32 v6, s36, v6
    v_mul_u32_u24 v6, 1024, v6
    v_lshrrev_b32 v7, 4, v2
    v_and_b32 v8, 7, v2
    v_add_u32 v9, 0, v7
    v_and_b32 v9, 7, v9
    v_xor_b32 v9, v9, v8
    v_lshlrev_b32 v9, 4, v9
    v_add_u32 v3, v6, v9
    v_add_u32 v9, 4, v7
    v_and_b32 v9, 7, v9
    v_xor_b32 v9, v9, v8
    v_lshlrev_b32 v9, 4, v9
    v_add_u32 v4, v6, v9
    v_lshrrev_b32 v6, 4, v2
    v_and_b32 v8, 15, v2
    v_lshlrev_b32 v9, 2, v6
    v_xor_b32 v9, v9, v8
    s_mul_i32 s36, s35, 16
    v_add_u32 v6, s36, v6
    v_mul_u32_u24 v6, 8192, v6
    v_lshlrev_b32 v9, 4, v9
    v_add_u32 v6, v6, v9
    s_lshl_b32 s36, s34, 1
    v_add_u32 v5, s36, v6
    s_lshr_b32 s37, s35, 1
    s_and_b32 s38, s35, 1
    v_and_b32 v6, 31, v2
    v_lshrrev_b32 v7, 5, v2
    s_mul_i32 s36, s37, 64
    v_add_u32 v8, s36, v6
    v_lshrrev_b32 v9, 1, v8
    v_and_b32 v9, 7, v9
    v_xor_b32 v9, v9, v7
    v_lshlrev_b32 v9, 4, v9
    v_lshlrev_b32 v8, 7, v8
    v_add_u32 v10, v8, v9
    v_xor_b32 v11, 32, v10
    v_xor_b32 v12, 64, v10
    v_xor_b32 v13, 96, v10
    v_lshrrev_b32 v6, 4, v2
    v_and_b32 v7, 15, v2
    v_lshrrev_b32 v8, 1, v6
    v_lshlrev_b32 v8, 3, v8
    v_lshrrev_b32 v9, 2, v7
    v_add_u32 v8, v8, v9
    v_mul_u32_u24 v8, 256, v8
    v_and_b32 v6, 1, v6
    v_lshlrev_b32 v6, 1, v6
    v_and_b32 v16, 3, v7
    v_lshrrev_b32 v16, 1, v16
    v_add_u32 v6, v6, v16
    s_mul_i32 s36, s38, 8
    v_add_u32 v6, s36, v6
    v_lshlrev_b32 v9, 2, v9
    v_and_b32 v16, 1, v7
    v_lshlrev_b32 v16, 3, v16
    v_add_u32 v8, v8, v16
    v_add_u32 v16, 0, v6
    v_xor_b32 v16, v16, v9
    v_lshlrev_b32 v16, 4, v16
    v_add_u32 v14, v8, v16
    v_add_u32 v14, 16384, v14
    v_add_u32 v16, 4, v6
    v_xor_b32 v16, v16, v9
    v_lshlrev_b32 v16, 4, v16
    v_add_u32 v15, v8, v16
    v_add_u32 v15, 16384, v15
    v_add_u32 v20, 0x10000, v10
    v_add_u32 v21, 0x10000, v11
    v_add_u32 v22, 0x10000, v12
    v_add_u32 v23, 0x10000, v13
    v_add_u32 v24, 0x10000, v14
    v_add_u32 v25, 0x10000, v15
    v_mov_b32 v60, 0
    v_mov_b32 v61, 0
    v_mov_b32 v62, 0
    v_mov_b32 v63, 0
    v_mov_b32 v64, 0
    v_mov_b32 v65, 0
    v_mov_b32 v66, 0
    v_mov_b32 v67, 0
    v_mov_b32 v68, 0
    v_mov_b32 v69, 0
    v_mov_b32 v70, 0
    v_mov_b32 v71, 0
    v_mov_b32 v72, 0
    v_mov_b32 v73, 0
    v_mov_b32 v74, 0
    v_mov_b32 v75, 0
    v_mov_b32 v76, 0
    v_mov_b32 v77, 0
    v_mov_b32 v78, 0
    v_mov_b32 v79, 0
    v_mov_b32 v80, 0
    v_mov_b32 v81, 0
    v_mov_b32 v82, 0
    v_mov_b32 v83, 0
    v_mov_b32 v84, 0
    v_mov_b32 v85, 0
    v_mov_b32 v86, 0
    v_mov_b32 v87, 0
    v_mov_b32 v88, 0
    v_mov_b32 v89, 0
    v_mov_b32 v90, 0
    v_mov_b32 v91, 0
    v_mov_b32 v92, 0
    v_mov_b32 v93, 0
    v_mov_b32 v94, 0
    v_mov_b32 v95, 0
    v_mov_b32 v96, 0
    v_mov_b32 v97, 0
    v_mov_b32 v98, 0
    v_mov_b32 v99, 0
    v_mov_b32 v100, 0
    v_mov_b32 v101, 0
    v_mov_b32 v102, 0
    v_mov_b32 v103, 0
    v_mov_b32 v104, 0
    v_mov_b32 v105, 0
    v_mov_b32 v106, 0
    v_mov_b32 v107, 0
    v_mov_b32 v108, 0
    v_mov_b32 v109, 0
    v_mov_b32 v110, 0
    v_mov_b32 v111, 0
    v_mov_b32 v112, 0
    v_mov_b32 v113, 0
    v_mov_b32 v114, 0
    v_mov_b32 v115, 0
    v_mov_b32 v116, 0
    v_mov_b32 v117, 0
    v_mov_b32 v118, 0
    v_mov_b32 v119, 0
    v_mov_b32 v120, 0
    v_mov_b32 v121, 0
    v_mov_b32 v122, 0
    v_mov_b32 v123, 0
    s_mul_i32 s40, s39, 1024
    s_mul_i32 s41, s39, 4194304
    s_mul_i32 s36, s35, 4096
    s_add_u32 m0, s36, 0
    s_add_u32 s36, s40, 0
    buffer_load_dwordx4 v3, s[8:11], s36 offen lds
    s_mul_i32 s36, s35, 4096
    s_add_u32 m0, s36, 1024
    s_add_u32 s36, s40, 8192
    buffer_load_dwordx4 v4, s[8:11], s36 offen lds
    s_mul_i32 s36, s35, 4096
    s_add_u32 m0, s36, 2048
    s_add_u32 s36, s40, 16384
    buffer_load_dwordx4 v3, s[8:11], s36 offen lds
    s_mul_i32 s36, s35, 4096
    s_add_u32 m0, s36, 3072
    s_add_u32 s36, s40, 24576
    buffer_load_dwordx4 v4, s[8:11], s36 offen lds
    s_mul_i32 s36, s35, 4096
    s_add_u32 m0, s36, 16384
    s_add_u32 s36, s41, 0
    buffer_load_dwordx4 v5, s[12:15], s36 offen lds
    s_mul_i32 s36, s35, 4096
    s_add_u32 m0, s36, 17408
    s_add_u32 s36, s41, 32768
    buffer_load_dwordx4 v5, s[12:15], s36 offen lds
    s_mul_i32 s36, s35, 4096
    s_add_u32 m0, s36, 18432
    s_add_u32 s36, s41, 65536
    buffer_load_dwordx4 v5, s[12:15], s36 offen lds
    s_mul_i32 s36, s35, 4096
    s_add_u32 m0, s36, 19456
    s_add_u32 s36, s41, 98304
    buffer_load_dwordx4 v5, s[12:15], s36 offen lds
    s_add_u32 s40, s40, 128
    s_add_u32 s41, s41, 524288
    s_mov_b32 s42, 3
qproj_loop2:
    s_waitcnt vmcnt(0)
    s_barrier
    s_mul_i32 s36, s35, 4096
    s_add_u32 m0, s36, 32768
    s_add_u32 s36, s40, 0
    buffer_load_dwordx4 v3, s[8:11], s36 offen lds
    s_mul_i32 s36, s35, 4096
    s_add_u32 m0, s36, 33792
    s_add_u32 s36, s40, 8192
    buffer_load_dwordx4 v4, s[8:11], s36 offen lds
    s_mul_i32 s36, s35, 4096
    s_add_u32 m0, s36, 34816
    s_add_u32 s36, s40, 16384
    buffer_load_dwordx4 v3, s[8:11], s36 offen lds
    s_mul_i32 s36, s35, 4096
    s_add_u32 m0, s36, 35840
    s_add_u32 s36, s40, 24576
    buffer_load_dwordx4 v4, s[8:11], s36 offen lds
    s_mul_i32 s36, s35, 4096
    s_add_u32 m0, s36, 49152
    s_add_u32 s36, s41, 0
    buffer_load_dwordx4 v5, s[12:15], s36 offen lds
    s_mul_i32 s36, s35, 4096
    s_add_u32 m0, s36, 50176
    s_add_u32 s36, s41, 32768
    buffer_load_dwordx4 v5, s[12:15], s36 offen lds
    s_mul_i32 s36, s35, 4096
    s_add_u32 m0, s36, 51200
    s_add_u32 s36, s41, 65536
    buffer_load_dwordx4 v5, s[12:15], s36 offen lds
    s_mul_i32 s36, s35, 4096
    s_add_u32 m0, s36, 52224
    s_add_u32 s36, s41, 98304
    buffer_load_dwordx4 v5, s[12:15], s36 offen lds
    s_add_u32 s40, s40, 128
    s_add_u32 s41, s41, 524288
    ds_read_b128 v[28:31], v10 offset:0
    ds_read_b128 v[32:35], v10 offset:4096
    ds_read_b64_tr_b16 v[36:37], v14 offset:0
    ds_read_b64_tr_b16 v[38:39], v14 offset:1024
    ds_read_b64_tr_b16 v[40:41], v15 offset:0
    ds_read_b64_tr_b16 v[42:43], v15 offset:1024
    ds_read_b128 v[44:47], v11 offset:0
    ds_read_b128 v[48:51], v11 offset:4096
    ds_read_b64_tr_b16 v[52:53], v14 offset:4096
    ds_read_b64_tr_b16 v[54:55], v14 offset:5120
    ds_read_b64_tr_b16 v[56:57], v15 offset:4096
    ds_read_b64_tr_b16 v[58:59], v15 offset:5120
    s_waitcnt lgkmcnt(6)
    v_mfma_f32_32x32x16_bf16 v[60:75], v[36:39], v[28:31], v[60:75]
    v_mfma_f32_32x32x16_bf16 v[76:91], v[40:43], v[28:31], v[76:91]
    v_mfma_f32_32x32x16_bf16 v[92:107], v[36:39], v[32:35], v[92:107]
    v_mfma_f32_32x32x16_bf16 v[108:123], v[40:43], v[32:35], v[108:123]
    ds_read_b128 v[28:31], v12 offset:0
    ds_read_b128 v[32:35], v12 offset:4096
    ds_read_b64_tr_b16 v[36:37], v14 offset:8192
    ds_read_b64_tr_b16 v[38:39], v14 offset:9216
    ds_read_b64_tr_b16 v[40:41], v15 offset:8192
    ds_read_b64_tr_b16 v[42:43], v15 offset:9216
    s_waitcnt lgkmcnt(6)
    v_mfma_f32_32x32x16_bf16 v[60:75], v[52:55], v[44:47], v[60:75]
    v_mfma_f32_32x32x16_bf16 v[76:91], v[56:59], v[44:47], v[76:91]
    v_mfma_f32_32x32x16_bf16 v[92:107], v[52:55], v[48:51], v[92:107]
    v_mfma_f32_32x32x16_bf16 v[108:123], v[56:59], v[48:51], v[108:123]
    ds_read_b128 v[44:47], v13 offset:0
    ds_read_b128 v[48:51], v13 offset:4096
    ds_read_b64_tr_b16 v[52:53], v14 offset:12288
    ds_read_b64_tr_b16 v[54:55], v14 offset:13312
    ds_read_b64_tr_b16 v[56:57], v15 offset:12288
    ds_read_b64_tr_b16 v[58:59], v15 offset:13312
    s_waitcnt lgkmcnt(6)
    v_mfma_f32_32x32x16_bf16 v[60:75], v[36:39], v[28:31], v[60:75]
    v_mfma_f32_32x32x16_bf16 v[76:91], v[40:43], v[28:31], v[76:91]
    v_mfma_f32_32x32x16_bf16 v[92:107], v[36:39], v[32:35], v[92:107]
    v_mfma_f32_32x32x16_bf16 v[108:123], v[40:43], v[32:35], v[108:123]
    s_waitcnt lgkmcnt(0)
    v_mfma_f32_32x32x16_bf16 v[60:75], v[52:55], v[44:47], v[60:75]
    v_mfma_f32_32x32x16_bf16 v[76:91], v[56:59], v[44:47], v[76:91]
    v_mfma_f32_32x32x16_bf16 v[92:107], v[52:55], v[48:51], v[92:107]
    v_mfma_f32_32x32x16_bf16 v[108:123], v[56:59], v[48:51], v[108:123]
    s_waitcnt vmcnt(0)
    s_barrier
    s_mul_i32 s36, s35, 4096
    s_add_u32 m0, s36, 0
    s_add_u32 s36, s40, 0
    buffer_load_dwordx4 v3, s[8:11], s36 offen lds
    s_mul_i32 s36, s35, 4096
    s_add_u32 m0, s36, 1024
    s_add_u32 s36, s40, 8192
    buffer_load_dwordx4 v4, s[8:11], s36 offen lds
    s_mul_i32 s36, s35, 4096
    s_add_u32 m0, s36, 2048
    s_add_u32 s36, s40, 16384
    buffer_load_dwordx4 v3, s[8:11], s36 offen lds
    s_mul_i32 s36, s35, 4096
    s_add_u32 m0, s36, 3072
    s_add_u32 s36, s40, 24576
    buffer_load_dwordx4 v4, s[8:11], s36 offen lds
    s_mul_i32 s36, s35, 4096
    s_add_u32 m0, s36, 16384
    s_add_u32 s36, s41, 0
    buffer_load_dwordx4 v5, s[12:15], s36 offen lds
    s_mul_i32 s36, s35, 4096
    s_add_u32 m0, s36, 17408
    s_add_u32 s36, s41, 32768
    buffer_load_dwordx4 v5, s[12:15], s36 offen lds
    s_mul_i32 s36, s35, 4096
    s_add_u32 m0, s36, 18432
    s_add_u32 s36, s41, 65536
    buffer_load_dwordx4 v5, s[12:15], s36 offen lds
    s_mul_i32 s36, s35, 4096
    s_add_u32 m0, s36, 19456
    s_add_u32 s36, s41, 98304
    buffer_load_dwordx4 v5, s[12:15], s36 offen lds
    s_add_u32 s40, s40, 128
    s_add_u32 s41, s41, 524288
    ds_read_b128 v[28:31], v10 offset:32768
    ds_read_b128 v[32:35], v10 offset:36864
    ds_read_b64_tr_b16 v[36:37], v14 offset:32768
    ds_read_b64_tr_b16 v[38:39], v14 offset:33792
    ds_read_b64_tr_b16 v[40:41], v15 offset:32768
    ds_read_b64_tr_b16 v[42:43], v15 offset:33792
    ds_read_b128 v[44:47], v11 offset:32768
    ds_read_b128 v[48:51], v11 offset:36864
    ds_read_b64_tr_b16 v[52:53], v14 offset:36864
    ds_read_b64_tr_b16 v[54:55], v14 offset:37888
    ds_read_b64_tr_b16 v[56:57], v15 offset:36864
    ds_read_b64_tr_b16 v[58:59], v15 offset:37888
    s_waitcnt lgkmcnt(6)
    v_mfma_f32_32x32x16_bf16 v[60:75], v[36:39], v[28:31], v[60:75]
    v_mfma_f32_32x32x16_bf16 v[76:91], v[40:43], v[28:31], v[76:91]
    v_mfma_f32_32x32x16_bf16 v[92:107], v[36:39], v[32:35], v[92:107]
    v_mfma_f32_32x32x16_bf16 v[108:123], v[40:43], v[32:35], v[108:123]
    ds_read_b128 v[28:31], v12 offset:32768
    ds_read_b128 v[32:35], v12 offset:36864
    ds_read_b64_tr_b16 v[36:37], v14 offset:40960
    ds_read_b64_tr_b16 v[38:39], v14 offset:41984
    ds_read_b64_tr_b16 v[40:41], v15 offset:40960
    ds_read_b64_tr_b16 v[42:43], v15 offset:41984
    s_waitcnt lgkmcnt(6)
    v_mfma_f32_32x32x16_bf16 v[60:75], v[52:55], v[44:47], v[60:75]
    v_mfma_f32_32x32x16_bf16 v[76:91], v[56:59], v[44:47], v[76:91]
    v_mfma_f32_32x32x16_bf16 v[92:107], v[52:55], v[48:51], v[92:107]
    v_mfma_f32_32x32x16_bf16 v[108:123], v[56:59], v[48:51], v[108:123]
    ds_read_b128 v[44:47], v13 offset:32768
    ds_read_b128 v[48:51], v13 offset:36864
    ds_read_b64_tr_b16 v[52:53], v14 offset:45056
    ds_read_b64_tr_b16 v[54:55], v14 offset:46080
    ds_read_b64_tr_b16 v[56:57], v15 offset:45056
    ds_read_b64_tr_b16 v[58:59], v15 offset:46080
    s_waitcnt lgkmcnt(6)
    v_mfma_f32_32x32x16_bf16 v[60:75], v[36:39], v[28:31], v[60:75]
    v_mfma_f32_32x32x16_bf16 v[76:91], v[40:43], v[28:31], v[76:91]
    v_mfma_f32_32x32x16_bf16 v[92:107], v[36:39], v[32:35], v[92:107]
    v_mfma_f32_32x32x16_bf16 v[108:123], v[40:43], v[32:35], v[108:123]
    s_waitcnt lgkmcnt(0)
    v_mfma_f32_32x32x16_bf16 v[60:75], v[52:55], v[44:47], v[60:75]
    v_mfma_f32_32x32x16_bf16 v[76:91], v[56:59], v[44:47], v[76:91]
    v_mfma_f32_32x32x16_bf16 v[92:107], v[52:55], v[48:51], v[92:107]
    v_mfma_f32_32x32x16_bf16 v[108:123], v[56:59], v[48:51], v[108:123]
    s_sub_u32 s42, s42, 1
    s_cmp_lg_u32 s42, 0
    s_cbranch_scc1 qproj_loop2
    s_waitcnt vmcnt(0)
    s_barrier
    s_mul_i32 s36, s35, 4096
    s_add_u32 m0, s36, 32768
    s_add_u32 s36, s40, 0
    buffer_load_dwordx4 v3, s[8:11], s36 offen lds
    s_mul_i32 s36, s35, 4096
    s_add_u32 m0, s36, 33792
    s_add_u32 s36, s40, 8192
    buffer_load_dwordx4 v4, s[8:11], s36 offen lds
    s_mul_i32 s36, s35, 4096
    s_add_u32 m0, s36, 34816
    s_add_u32 s36, s40, 16384
    buffer_load_dwordx4 v3, s[8:11], s36 offen lds
    s_mul_i32 s36, s35, 4096
    s_add_u32 m0, s36, 35840
    s_add_u32 s36, s40, 24576
    buffer_load_dwordx4 v4, s[8:11], s36 offen lds
    s_mul_i32 s36, s35, 4096
    s_add_u32 m0, s36, 49152
    s_add_u32 s36, s41, 0
    buffer_load_dwordx4 v5, s[12:15], s36 offen lds
    s_mul_i32 s36, s35, 4096
    s_add_u32 m0, s36, 50176
    s_add_u32 s36, s41, 32768
    buffer_load_dwordx4 v5, s[12:15], s36 offen lds
    s_mul_i32 s36, s35, 4096
    s_add_u32 m0, s36, 51200
    s_add_u32 s36, s41, 65536
    buffer_load_dwordx4 v5, s[12:15], s36 offen lds
    s_mul_i32 s36, s35, 4096
    s_add_u32 m0, s36, 52224
    s_add_u32 s36, s41, 98304
    buffer_load_dwordx4 v5, s[12:15], s36 offen lds
    s_add_u32 s40, s40, 128
    s_add_u32 s41, s41, 524288
    ds_read_b128 v[28:31], v10 offset:0
    ds_read_b128 v[32:35], v10 offset:4096
    ds_read_b64_tr_b16 v[36:37], v14 offset:0
    ds_read_b64_tr_b16 v[38:39], v14 offset:1024
    ds_read_b64_tr_b16 v[40:41], v15 offset:0
    ds_read_b64_tr_b16 v[42:43], v15 offset:1024
    ds_read_b128 v[44:47], v11 offset:0
    ds_read_b128 v[48:51], v11 offset:4096
    ds_read_b64_tr_b16 v[52:53], v14 offset:4096
    ds_read_b64_tr_b16 v[54:55], v14 offset:5120
    ds_read_b64_tr_b16 v[56:57], v15 offset:4096
    ds_read_b64_tr_b16 v[58:59], v15 offset:5120
    s_waitcnt lgkmcnt(6)
    v_mfma_f32_32x32x16_bf16 v[60:75], v[36:39], v[28:31], v[60:75]
    v_mfma_f32_32x32x16_bf16 v[76:91], v[40:43], v[28:31], v[76:91]
    v_mfma_f32_32x32x16_bf16 v[92:107], v[36:39], v[32:35], v[92:107]
    v_mfma_f32_32x32x16_bf16 v[108:123], v[40:43], v[32:35], v[108:123]
    ds_read_b128 v[28:31], v12 offset:0
    ds_read_b128 v[32:35], v12 offset:4096
    ds_read_b64_tr_b16 v[36:37], v14 offset:8192
    ds_read_b64_tr_b16 v[38:39], v14 offset:9216
    ds_read_b64_tr_b16 v[40:41], v15 offset:8192
    ds_read_b64_tr_b16 v[42:43], v15 offset:9216
    s_waitcnt lgkmcnt(6)
    v_mfma_f32_32x32x16_bf16 v[60:75], v[52:55], v[44:47], v[60:75]
    v_mfma_f32_32x32x16_bf16 v[76:91], v[56:59], v[44:47], v[76:91]
    v_mfma_f32_32x32x16_bf16 v[92:107], v[52:55], v[48:51], v[92:107]
    v_mfma_f32_32x32x16_bf16 v[108:123], v[56:59], v[48:51], v[108:123]
    ds_read_b128 v[44:47], v13 offset:0
    ds_read_b128 v[48:51], v13 offset:4096
    ds_read_b64_tr_b16 v[52:53], v14 offset:12288
    ds_read_b64_tr_b16 v[54:55], v14 offset:13312
    ds_read_b64_tr_b16 v[56:57], v15 offset:12288
    ds_read_b64_tr_b16 v[58:59], v15 offset:13312
    s_waitcnt lgkmcnt(6)
    v_mfma_f32_32x32x16_bf16 v[60:75], v[36:39], v[28:31], v[60:75]
    v_mfma_f32_32x32x16_bf16 v[76:91], v[40:43], v[28:31], v[76:91]
    v_mfma_f32_32x32x16_bf16 v[92:107], v[36:39], v[32:35], v[92:107]
    v_mfma_f32_32x32x16_bf16 v[108:123], v[40:43], v[32:35], v[108:123]
    s_waitcnt lgkmcnt(0)
    v_mfma_f32_32x32x16_bf16 v[60:75], v[52:55], v[44:47], v[60:75]
    v_mfma_f32_32x32x16_bf16 v[76:91], v[56:59], v[44:47], v[76:91]
    v_mfma_f32_32x32x16_bf16 v[92:107], v[52:55], v[48:51], v[92:107]
    v_mfma_f32_32x32x16_bf16 v[108:123], v[56:59], v[48:51], v[108:123]
    s_waitcnt vmcnt(0)
    s_barrier
    ds_read_b128 v[28:31], v10 offset:32768
    ds_read_b128 v[32:35], v10 offset:36864
    ds_read_b64_tr_b16 v[36:37], v14 offset:32768
    ds_read_b64_tr_b16 v[38:39], v14 offset:33792
    ds_read_b64_tr_b16 v[40:41], v15 offset:32768
    ds_read_b64_tr_b16 v[42:43], v15 offset:33792
    ds_read_b128 v[44:47], v11 offset:32768
    ds_read_b128 v[48:51], v11 offset:36864
    ds_read_b64_tr_b16 v[52:53], v14 offset:36864
    ds_read_b64_tr_b16 v[54:55], v14 offset:37888
    ds_read_b64_tr_b16 v[56:57], v15 offset:36864
    ds_read_b64_tr_b16 v[58:59], v15 offset:37888
    s_waitcnt lgkmcnt(6)
    v_mfma_f32_32x32x16_bf16 v[60:75], v[36:39], v[28:31], v[60:75]
    v_mfma_f32_32x32x16_bf16 v[76:91], v[40:43], v[28:31], v[76:91]
    v_mfma_f32_32x32x16_bf16 v[92:107], v[36:39], v[32:35], v[92:107]
    v_mfma_f32_32x32x16_bf16 v[108:123], v[40:43], v[32:35], v[108:123]
    ds_read_b128 v[28:31], v12 offset:32768
    ds_read_b128 v[32:35], v12 offset:36864
    ds_read_b64_tr_b16 v[36:37], v14 offset:40960
    ds_read_b64_tr_b16 v[38:39], v14 offset:41984
    ds_read_b64_tr_b16 v[40:41], v15 offset:40960
    ds_read_b64_tr_b16 v[42:43], v15 offset:41984
    s_waitcnt lgkmcnt(6)
    v_mfma_f32_32x32x16_bf16 v[60:75], v[52:55], v[44:47], v[60:75]
    v_mfma_f32_32x32x16_bf16 v[76:91], v[56:59], v[44:47], v[76:91]
    v_mfma_f32_32x32x16_bf16 v[92:107], v[52:55], v[48:51], v[92:107]
    v_mfma_f32_32x32x16_bf16 v[108:123], v[56:59], v[48:51], v[108:123]
    ds_read_b128 v[44:47], v13 offset:32768
    ds_read_b128 v[48:51], v13 offset:36864
    ds_read_b64_tr_b16 v[52:53], v14 offset:45056
    ds_read_b64_tr_b16 v[54:55], v14 offset:46080
    ds_read_b64_tr_b16 v[56:57], v15 offset:45056
    ds_read_b64_tr_b16 v[58:59], v15 offset:46080
    s_waitcnt lgkmcnt(6)
    v_mfma_f32_32x32x16_bf16 v[60:75], v[36:39], v[28:31], v[60:75]
    v_mfma_f32_32x32x16_bf16 v[76:91], v[40:43], v[28:31], v[76:91]
    v_mfma_f32_32x32x16_bf16 v[92:107], v[36:39], v[32:35], v[92:107]
    v_mfma_f32_32x32x16_bf16 v[108:123], v[40:43], v[32:35], v[108:123]
    s_waitcnt lgkmcnt(0)
    v_mfma_f32_32x32x16_bf16 v[60:75], v[52:55], v[44:47], v[60:75]
    v_mfma_f32_32x32x16_bf16 v[76:91], v[56:59], v[44:47], v[76:91]
    v_mfma_f32_32x32x16_bf16 v[92:107], v[52:55], v[48:51], v[92:107]
    v_mfma_f32_32x32x16_bf16 v[108:123], v[56:59], v[48:51], v[108:123]
    s_nop 15
    s_nop 7
    s_barrier
    v_and_b32 v6, 31, v2
    v_mul_u32_u24 v6, 144, v6
    v_lshrrev_b32 v7, 5, v2
    v_lshlrev_b32 v7, 3, v7
    v_add_u32 v6, v6, v7
    s_mul_i32 s36, s35, 9216
    v_add_u32 v6, s36, v6
    v_cvt_pk_bf16_f32 v60, v60, v61
    v_cvt_pk_bf16_f32 v61, v62, v63
    ds_write_b64 v6, v[60:61] offset:0
    v_cvt_pk_bf16_f32 v64, v64, v65
    v_cvt_pk_bf16_f32 v65, v66, v67
    ds_write_b64 v6, v[64:65] offset:16
    v_cvt_pk_bf16_f32 v68, v68, v69
    v_cvt_pk_bf16_f32 v69, v70, v71
    ds_write_b64 v6, v[68:69] offset:32
    v_cvt_pk_bf16_f32 v72, v72, v73
    v_cvt_pk_bf16_f32 v73, v74, v75
    ds_write_b64 v6, v[72:73] offset:48
    v_cvt_pk_bf16_f32 v76, v76, v77
    v_cvt_pk_bf16_f32 v77, v78, v79
    ds_write_b64 v6, v[76:77] offset:64
    v_cvt_pk_bf16_f32 v80, v80, v81
    v_cvt_pk_bf16_f32 v81, v82, v83
    ds_write_b64 v6, v[80:81] offset:80
    v_cvt_pk_bf16_f32 v84, v84, v85
    v_cvt_pk_bf16_f32 v85, v86, v87
    ds_write_b64 v6, v[84:85] offset:96
    v_cvt_pk_bf16_f32 v88, v88, v89
    v_cvt_pk_bf16_f32 v89, v90, v91
    ds_write_b64 v6, v[88:89] offset:112
    v_cvt_pk_bf16_f32 v92, v92, v93
    v_cvt_pk_bf16_f32 v93, v94, v95
    ds_write_b64 v6, v[92:93] offset:4608
    v_cvt_pk_bf16_f32 v96, v96, v97
    v_cvt_pk_bf16_f32 v97, v98, v99
    ds_write_b64 v6, v[96:97] offset:4624
    v_cvt_pk_bf16_f32 v100, v100, v101
    v_cvt_pk_bf16_f32 v101, v102, v103
    ds_write_b64 v6, v[100:101] offset:4640
    v_cvt_pk_bf16_f32 v104, v104, v105
    v_cvt_pk_bf16_f32 v105, v106, v107
    ds_write_b64 v6, v[104:105] offset:4656
    v_cvt_pk_bf16_f32 v108, v108, v109
    v_cvt_pk_bf16_f32 v109, v110, v111
    ds_write_b64 v6, v[108:109] offset:4672
    v_cvt_pk_bf16_f32 v112, v112, v113
    v_cvt_pk_bf16_f32 v113, v114, v115
    ds_write_b64 v6, v[112:113] offset:4688
    v_cvt_pk_bf16_f32 v116, v116, v117
    v_cvt_pk_bf16_f32 v117, v118, v119
    ds_write_b64 v6, v[116:117] offset:4704
    v_cvt_pk_bf16_f32 v120, v120, v121
    v_cvt_pk_bf16_f32 v121, v122, v123
    ds_write_b64 v6, v[120:121] offset:4720
    v_lshrrev_b32 v8, 3, v2
    v_and_b32 v9, 7, v2
    v_mul_u32_u24 v6, 144, v8
    v_lshlrev_b32 v7, 4, v9
    v_add_u32 v6, v6, v7
    v_add_u32 v6, s36, v6
    s_mul_i32 s36, s37, 64
    s_add_u32 s36, s36, s33
    v_add_u32 v8, s36, v8
    v_lshlrev_b32 v9, 3, v9
    s_mul_i32 s36, s38, 64
    s_add_u32 s36, s36, s34
    v_add_u32 v9, s36, v9
    v_mul_u32_u24 v10, 8192, v8
    v_lshlrev_b32 v11, 1, v9
    v_add_u32 v10, v10, v11
    ds_read_b128 v[60:63], v6 offset:0
    ds_read_b128 v[72:75], v6 offset:1152
    ds_read_b128 v[84:87], v6 offset:2304
    ds_read_b128 v[96:99], v6 offset:3456
    s_waitcnt vmcnt(0) lgkmcnt(3)
    s_mov_b32 s36, 0
    buffer_store_dwordx4 v[60:63], v10, s[16:19], s36 offen
    s_waitcnt vmcnt(1) lgkmcnt(2)
    s_mov_b32 s36, 65536
    buffer_store_dwordx4 v[72:75], v10, s[16:19], s36 offen
    s_waitcnt vmcnt(2) lgkmcnt(1)
    s_mov_b32 s36, 131072
    buffer_store_dwordx4 v[84:87], v10, s[16:19], s36 offen
    s_waitcnt vmcnt(3) lgkmcnt(0)
    s_mov_b32 s36, 196608
    buffer_store_dwordx4 v[96:99], v10, s[16:19], s36 offen
    ds_read_b128 v[60:63], v6 offset:4608
    ds_read_b128 v[72:75], v6 offset:5760
    ds_read_b128 v[84:87], v6 offset:6912
    ds_read_b128 v[96:99], v6 offset:8064
    s_waitcnt vmcnt(0) lgkmcnt(3)
    s_mov_b32 s36, 262144
    buffer_store_dwordx4 v[60:63], v10, s[16:19], s36 offen
    s_waitcnt vmcnt(1) lgkmcnt(2)
    s_mov_b32 s36, 327680
    buffer_store_dwordx4 v[72:75], v10, s[16:19], s36 offen
    s_waitcnt vmcnt(2) lgkmcnt(1)
    s_mov_b32 s36, 393216
    buffer_store_dwordx4 v[84:87], v10, s[16:19], s36 offen
    s_waitcnt vmcnt(3) lgkmcnt(0)
    s_mov_b32 s36, 458752
    buffer_store_dwordx4 v[96:99], v10, s[16:19], s36 offen
qproj_done1:
    s_endpgm
.globl attn_kernel
.p2align 8
.type attn_kernel,@function
attn_kernel:
    s_cmp_ge_u32 s2, 512
    s_cbranch_scc1 attn_done1
    s_load_dwordx2 s[4:5], s[0:1], 8
    s_load_dwordx2 s[6:7], s[0:1], 16
    s_load_dwordx2 s[28:29], s[0:1], 112
    s_waitcnt lgkmcnt(0)
    s_and_b32 s30, s2, 7
    s_lshl_b32 s30, s30, 2
    s_lshr_b32 s31, s2, 3
    s_and_b32 s31, s31, 3
    s_add_u32 s30, s30, s31
    s_lshr_b32 s31, s2, 5
    s_lshl_b32 s32, s30, 19
    s_add_u32 s8, s4, s32
    s_addc_u32 s9, s5, 0
    s_and_b32 s9, s9, 0xffff
    s_mov_b32 s10, 0x80000
    s_mov_b32 s11, 0x20000
    s_add_u32 s12, s6, s32
    s_addc_u32 s13, s7, 0
    s_and_b32 s13, s13, 0xffff
    s_mov_b32 s14, 0x80000
    s_mov_b32 s15, 0x20000
    s_add_u32 s16, s28, 16777216
    s_addc_u32 s17, s29, 0
    s_and_b32 s17, s17, 0xffff
    s_mov_b32 s18, 16777216
    s_mov_b32 s19, 0x20000
    s_add_u32 s20, s28, 33554432
    s_addc_u32 s21, s29, 0
    s_and_b32 s21, s21, 0xffff
    s_mov_b32 s22, 16777216
    s_mov_b32 s23, 0x20000
    v_lshrrev_b32 v1, 6, v0
    v_and_b32 v2, 63, v0
    v_readfirstlane_b32 s35, v1
    v_and_b32 v3, 31, v2
    v_lshrrev_b32 v4, 5, v2
    s_lshl_b32 s33, s31, 7
    s_lshl_b32 s34, s35, 5
    s_add_u32 s33, s33, s34
    v_add_u32 v5, s33, v3
    v_lshlrev_b32 v6, 13, v5
    s_lshl_b32 s34, s30, 8
    v_add_u32 v6, s34, v6
    v_lshlrev_b32 v7, 4, v4
    v_add_u32 v7, v6, v7
    buffer_load_dwordx4 v[32:35], v7, s[16:19], 0 offen offset:0
    buffer_load_dwordx4 v[36:39], v7, s[16:19], 0 offen offset:32
    buffer_load_dwordx4 v[40:43], v7, s[16:19], 0 offen offset:64
    buffer_load_dwordx4 v[44:47], v7, s[16:19], 0 offen offset:96
    buffer_load_dwordx4 v[48:51], v7, s[16:19], 0 offen offset:128
    buffer_load_dwordx4 v[52:55], v7, s[16:19], 0 offen offset:160
    buffer_load_dwordx4 v[56:59], v7, s[16:19], 0 offen offset:192
    buffer_load_dwordx4 v[60:63], v7, s[16:19], 0 offen offset:224
    v_lshrrev_b32 v13, 4, v2
    v_and_b32 v14, 15, v2
    s_lshl_b32 s34, s35, 4
    v_add_u32 v15, s34, v13
    v_lshlrev_b32 v15, 8, v15
    v_xor_b32 v16, v14, v13
    v_lshlrev_b32 v16, 4, v16
    v_add_u32 v8, v15, v16
    v_xor_b32 v9, 64, v8
    v_xor_b32 v10, 128, v8
    v_xor_b32 v11, 192, v8
    v_lshlrev_b32 v16, 2, v13
    v_xor_b32 v16, v16, v14
    v_lshlrev_b32 v16, 4, v16
    v_add_u32 v12, v15, v16
    v_and_b32 v13, 15, v3
    v_xor_b32 v13, v13, v4
    v_lshlrev_b32 v13, 4, v13
    v_lshlrev_b32 v14, 8, v3
    v_add_u32 v16, v13, v14
    v_xor_b32 v17, 32, v16
    v_xor_b32 v18, 64, v16
    v_xor_b32 v19, 96, v16
    v_xor_b32 v20, 128, v16
    v_xor_b32 v21, 160, v16
    v_xor_b32 v22, 192, v16
    v_xor_b32 v23, 224, v16
    v_lshrrev_b32 v13, 4, v2
    v_and_b32 v14, 15, v2
    v_lshrrev_b32 v15, 1, v13
    v_lshlrev_b32 v15, 2, v15
    v_lshrrev_b32 v28, 2, v14
    v_add_u32 v15, v15, v28
    v_lshlrev_b32 v15, 8, v15
    v_and_b32 v29, 1, v14
    v_lshlrev_b32 v29, 3, v29
    v_add_u32 v15, v15, v29
    v_and_b32 v13, 1, v13
    v_lshlrev_b32 v13, 1, v13
    v_and_b32 v29, 3, v14
    v_lshrrev_b32 v29, 1, v29
    v_add_u32 v13, v13, v29
    v_lshlrev_b32 v28, 2, v28
    v_add_u32 v29, 0, v13
    v_xor_b32 v29, v29, v28
    v_lshlrev_b32 v29, 4, v29
    v_add_u32 v24, v15, v29
    v_add_u32 v24, 16384, v24
    v_add_u32 v29, 4, v13
    v_xor_b32 v29, v29, v28
    v_lshlrev_b32 v29, 4, v29
    v_add_u32 v25, v15, v29
    v_add_u32 v25, 16384, v25
    v_add_u32 v29, 8, v13
    v_xor_b32 v29, v29, v28
    v_lshlrev_b32 v29, 4, v29
    v_add_u32 v26, v15, v29
    v_add_u32 v26, 16384, v26
    v_add_u32 v29, 12, v13
    v_xor_b32 v29, v29, v28
    v_lshlrev_b32 v29, 4, v29
    v_add_u32 v27, v15, v29
    v_add_u32 v27, 16384, v27
    v_mov_b32 v96, 0
    v_mov_b32 v97, 0
    v_mov_b32 v98, 0
    v_mov_b32 v99, 0
    v_mov_b32 v100, 0
    v_mov_b32 v101, 0
    v_mov_b32 v102, 0
    v_mov_b32 v103, 0
    v_mov_b32 v104, 0
    v_mov_b32 v105, 0
    v_mov_b32 v106, 0
    v_mov_b32 v107, 0
    v_mov_b32 v108, 0
    v_mov_b32 v109, 0
    v_mov_b32 v110, 0
    v_mov_b32 v111, 0
    v_mov_b32 v112, 0
    v_mov_b32 v113, 0
    v_mov_b32 v114, 0
    v_mov_b32 v115, 0
    v_mov_b32 v116, 0
    v_mov_b32 v117, 0
    v_mov_b32 v118, 0
    v_mov_b32 v119, 0
    v_mov_b32 v120, 0
    v_mov_b32 v121, 0
    v_mov_b32 v122, 0
    v_mov_b32 v123, 0
    v_mov_b32 v124, 0
    v_mov_b32 v125, 0
    v_mov_b32 v126, 0
    v_mov_b32 v127, 0
    v_mov_b32 v128, 0
    v_mov_b32 v129, 0
    v_mov_b32 v130, 0
    v_mov_b32 v131, 0
    v_mov_b32 v132, 0
    v_mov_b32 v133, 0
    v_mov_b32 v134, 0
    v_mov_b32 v135, 0
    v_mov_b32 v136, 0
    v_mov_b32 v137, 0
    v_mov_b32 v138, 0
    v_mov_b32 v139, 0
    v_mov_b32 v140, 0
    v_mov_b32 v141, 0
    v_mov_b32 v142, 0
    v_mov_b32 v143, 0
    v_mov_b32 v144, 0
    v_mov_b32 v145, 0
    v_mov_b32 v146, 0
    v_mov_b32 v147, 0
    v_mov_b32 v148, 0
    v_mov_b32 v149, 0
    v_mov_b32 v150, 0
    v_mov_b32 v151, 0
    v_mov_b32 v152, 0
    v_mov_b32 v153, 0
    v_mov_b32 v154, 0
    v_mov_b32 v155, 0
    v_mov_b32 v156, 0
    v_mov_b32 v157, 0
    v_mov_b32 v158, 0
    v_mov_b32 v159, 0
    v_mov_b32 v28, 0xff800000
    v_mov_b32 v29, 0
    s_mov_b32 s40, 1040356334
    s_mov_b32 s41, 0
    s_mov_b32 s43, 0
    s_lshl_b32 s36, s35, 12
    s_add_u32 m0, s36, 0
    s_add_u32 s36, s41, 0
    buffer_load_dwordx4 v8, s[8:11], s36 offen lds
    s_lshl_b32 s36, s35, 12
    s_add_u32 m0, s36, 1024
    s_add_u32 s36, s41, 1024
    buffer_load_dwordx4 v9, s[8:11], s36 offen lds
    s_lshl_b32 s36, s35, 12
    s_add_u32 m0, s36, 2048
    s_add_u32 s36, s41, 2048
    buffer_load_dwordx4 v10, s[8:11], s36 offen lds
    s_lshl_b32 s36, s35, 12
    s_add_u32 m0, s36, 3072
    s_add_u32 s36, s41, 3072
    buffer_load_dwordx4 v11, s[8:11], s36 offen lds
    s_add_u32 s41, s41, 16384
    s_lshl_b32 s36, s35, 12
    s_add_u32 m0, s36, 32768
    s_add_u32 s36, s41, 0
    buffer_load_dwordx4 v8, s[8:11], s36 offen lds
    s_lshl_b32 s36, s35, 12
    s_add_u32 m0, s36, 33792
    s_add_u32 s36, s41, 1024
    buffer_load_dwordx4 v9, s[8:11], s36 offen lds
    s_lshl_b32 s36, s35, 12
    s_add_u32 m0, s36, 34816
    s_add_u32 s36, s41, 2048
    buffer_load_dwordx4 v10, s[8:11], s36 offen lds
    s_lshl_b32 s36, s35, 12
    s_add_u32 m0, s36, 35840
    s_add_u32 s36, s41, 3072
    buffer_load_dwordx4 v11, s[8:11], s36 offen lds
    s_add_u32 s41, s41, 16384
    s_lshl_b32 s36, s35, 12
    s_add_u32 m0, s36, 16384
    s_add_u32 s36, s43, 0
    buffer_load_dwordx4 v12, s[12:15], s36 offen lds
    s_lshl_b32 s36, s35, 12
    s_add_u32 m0, s36, 17408
    s_add_u32 s36, s43, 1024
    buffer_load_dwordx4 v12, s[12:15], s36 offen lds
    s_lshl_b32 s36, s35, 12
    s_add_u32 m0, s36, 18432
    s_add_u32 s36, s43, 2048
    buffer_load_dwordx4 v12, s[12:15], s36 offen lds
    s_lshl_b32 s36, s35, 12
    s_add_u32 m0, s36, 19456
    s_add_u32 s36, s43, 3072
    buffer_load_dwordx4 v12, s[12:15], s36 offen lds
    s_add_u32 s43, s43, 16384
    s_waitcnt vmcnt(8)
    s_barrier
    ds_read_b128 v[176:179], v16 offset:0
    ds_read_b128 v[180:183], v17 offset:0
    ds_read_b128 v[184:187], v18 offset:0
    ds_read_b128 v[188:191], v19 offset:0
    s_waitcnt lgkmcnt(3)
    v_mfma_f32_32x32x16_bf16 v[64:79], v[176:179], v[32:35], 0
    ds_read_b128 v[176:179], v20 offset:0
    s_waitcnt lgkmcnt(3)
    v_mfma_f32_32x32x16_bf16 v[64:79], v[180:183], v[36:39], v[64:79]
    ds_read_b128 v[180:183], v21 offset:0
    s_waitcnt lgkmcnt(3)
    v_mfma_f32_32x32x16_bf16 v[64:79], v[184:187], v[40:43], v[64:79]
    ds_read_b128 v[184:187], v22 offset:0
    s_waitcnt lgkmcnt(3)
    v_mfma_f32_32x32x16_bf16 v[64:79], v[188:191], v[44:47], v[64:79]
    ds_read_b128 v[188:191], v23 offset:0
    s_waitcnt lgkmcnt(3)
    v_mfma_f32_32x32x16_bf16 v[64:79], v[176:179], v[48:51], v[64:79]
    ds_read_b128 v[176:179], v16 offset:8192
    s_waitcnt lgkmcnt(3)
    v_mfma_f32_32x32x16_bf16 v[64:79], v[180:183], v[52:55], v[64:79]
    ds_read_b128 v[180:183], v17 offset:8192
    s_waitcnt lgkmcnt(3)
    v_mfma_f32_32x32x16_bf16 v[64:79], v[184:187], v[56:59], v[64:79]
    ds_read_b128 v[184:187], v18 offset:8192
    s_waitcnt lgkmcnt(3)
    v_mfma_f32_32x32x16_bf16 v[64:79], v[188:191], v[60:63], v[64:79]
    ds_read_b128 v[188:191], v19 offset:8192
    s_waitcnt lgkmcnt(3)
    v_mfma_f32_32x32x16_bf16 v[80:95], v[176:179], v[32:35], 0
    ds_read_b128 v[176:179], v20 offset:8192
    s_waitcnt lgkmcnt(3)
    v_mfma_f32_32x32x16_bf16 v[80:95], v[180:183], v[36:39], v[80:95]
    ds_read_b128 v[180:183], v21 offset:8192
    s_waitcnt lgkmcnt(3)
    v_mfma_f32_32x32x16_bf16 v[80:95], v[184:187], v[40:43], v[80:95]
    ds_read_b128 v[184:187], v22 offset:8192
    s_waitcnt lgkmcnt(3)
    v_mfma_f32_32x32x16_bf16 v[80:95], v[188:191], v[44:47], v[80:95]
    ds_read_b128 v[188:191], v23 offset:8192
    s_waitcnt lgkmcnt(3)
    v_mfma_f32_32x32x16_bf16 v[80:95], v[176:179], v[48:51], v[80:95]
    s_waitcnt lgkmcnt(2)
    v_mfma_f32_32x32x16_bf16 v[80:95], v[180:183], v[52:55], v[80:95]
    s_waitcnt lgkmcnt(1)
    v_mfma_f32_32x32x16_bf16 v[80:95], v[184:187], v[56:59], v[80:95]
    s_waitcnt lgkmcnt(0)
    v_mfma_f32_32x32x16_bf16 v[80:95], v[188:191], v[60:63], v[80:95]
    s_mov_b32 s42, 16
attn_loop2:
    s_waitcnt vmcnt(0)
    s_barrier
    s_lshl_b32 s36, s35, 12
    s_add_u32 m0, s36, 0
    s_add_u32 s36, s41, 0
    buffer_load_dwordx4 v8, s[8:11], s36 offen lds
    s_lshl_b32 s36, s35, 12
    s_add_u32 m0, s36, 1024
    s_add_u32 s36, s41, 1024
    buffer_load_dwordx4 v9, s[8:11], s36 offen lds
    s_lshl_b32 s36, s35, 12
    s_add_u32 m0, s36, 2048
    s_add_u32 s36, s41, 2048
    buffer_load_dwordx4 v10, s[8:11], s36 offen lds
    s_lshl_b32 s36, s35, 12
    s_add_u32 m0, s36, 3072
    s_add_u32 s36, s41, 3072
    buffer_load_dwordx4 v11, s[8:11], s36 offen lds
    s_add_u32 s41, s41, 16384
    s_lshl_b32 s36, s35, 12
    s_add_u32 m0, s36, 49152
    s_add_u32 s36, s43, 0
    buffer_load_dwordx4 v12, s[12:15], s36 offen lds
    s_lshl_b32 s36, s35, 12
    s_add_u32 m0, s36, 50176
    s_add_u32 s36, s43, 1024
    buffer_load_dwordx4 v12, s[12:15], s36 offen lds
    s_lshl_b32 s36, s35, 12
    s_add_u32 m0, s36, 51200
    s_add_u32 s36, s43, 2048
    buffer_load_dwordx4 v12, s[12:15], s36 offen lds
    s_lshl_b32 s36, s35, 12
    s_add_u32 m0, s36, 52224
    s_add_u32 s36, s43, 3072
    buffer_load_dwordx4 v12, s[12:15], s36 offen lds
    s_add_u32 s43, s43, 16384
    ds_read_b128 v[176:179], v16 offset:32768
    ds_read_b128 v[180:183], v17 offset:32768
    ds_read_b128 v[184:187], v18 offset:32768
    ds_read_b128 v[188:191], v19 offset:32768
    s_waitcnt lgkmcnt(3)
    v_mfma_f32_32x32x16_bf16 v[208:223], v[176:179], v[32:35], 0
    v_max3_f32 v30, v64, v65, v66
    v_max3_f32 v30, v30, v67, v68
    v_max3_f32 v30, v30, v69, v70
    v_max3_f32 v30, v30, v71, v72
    v_max3_f32 v30, v30, v73, v74
    v_max3_f32 v30, v30, v75, v76
    v_max3_f32 v30, v30, v77, v78
    v_max3_f32 v30, v30, v79, v80
    v_max3_f32 v30, v30, v81, v82
    v_max3_f32 v30, v30, v83, v84
    v_max3_f32 v30, v30, v85, v86
    v_max3_f32 v30, v30, v87, v88
    v_max3_f32 v30, v30, v89, v90
    ds_read_b128 v[176:179], v20 offset:32768
    s_waitcnt lgkmcnt(3)
    v_mfma_f32_32x32x16_bf16 v[208:223], v[180:183], v[36:39], v[208:223]
    v_max3_f32 v30, v30, v91, v92
    v_max3_f32 v30, v30, v93, v94
    v_max_f32 v30, v30, v95
    v_mov_b32 v31, v30
    s_nop 1
    v_permlane32_swap_b32 v30, v31
    v_max_f32 v30, v30, v31
    v_mul_f32 v30, s40, v30
    v_max_f32 v30, v30, v28
    v_sub_f32 v13, v28, v30
    v_exp_f32 v13, v13
    v_mov_b32 v28, v30
    v_mul_f32 v30, -1.0, v30
    ds_read_b128 v[180:183], v21 offset:32768
    s_waitcnt lgkmcnt(3)
    v_mfma_f32_32x32x16_bf16 v[208:223], v[184:187], v[40:43], v[208:223]
    v_fma_f32 v64, v64, s40, v30
    v_fma_f32 v65, v65, s40, v30
    v_fma_f32 v66, v66, s40, v30
    v_exp_f32 v64, v64
    v_fma_f32 v67, v67, s40, v30
    v_exp_f32 v65, v65
    v_fma_f32 v68, v68, s40, v30
    v_exp_f32 v66, v66
    v_fma_f32 v69, v69, s40, v30
    v_exp_f32 v67, v67
    v_fma_f32 v70, v70, s40, v30
    v_exp_f32 v68, v68
    v_fma_f32 v71, v71, s40, v30
    ds_read_b128 v[184:187], v22 offset:32768
    s_waitcnt lgkmcnt(3)
    v_mfma_f32_32x32x16_bf16 v[208:223], v[188:191], v[44:47], v[208:223]
    v_exp_f32 v69, v69
    v_fma_f32 v72, v72, s40, v30
    v_exp_f32 v70, v70
    v_fma_f32 v73, v73, s40, v30
    v_exp_f32 v71, v71
    v_fma_f32 v74, v74, s40, v30
    v_exp_f32 v72, v72
    v_fma_f32 v75, v75, s40, v30
    v_exp_f32 v73, v73
    v_fma_f32 v76, v76, s40, v30
    v_exp_f32 v74, v74
    v_fma_f32 v77, v77, s40, v30
    v_exp_f32 v75, v75
    ds_read_b128 v[188:191], v23 offset:32768
    s_waitcnt lgkmcnt(3)
    v_mfma_f32_32x32x16_bf16 v[208:223], v[176:179], v[48:51], v[208:223]
    v_fma_f32 v78, v78, s40, v30
    v_exp_f32 v76, v76
    v_fma_f32 v79, v79, s40, v30
    v_exp_f32 v77, v77
    v_fma_f32 v80, v80, s40, v30
    v_exp_f32 v78, v78
    v_fma_f32 v81, v81, s40, v30
    v_exp_f32 v79, v79
    v_fma_f32 v82, v82, s40, v30
    v_exp_f32 v80, v80
    v_fma_f32 v83, v83, s40, v30
    v_exp_f32 v81, v81
    v_fma_f32 v84, v84, s40, v30
    ds_read_b128 v[176:179], v16 offset:40960
    s_waitcnt lgkmcnt(3)
    v_mfma_f32_32x32x16_bf16 v[208:223], v[180:183], v[52:55], v[208:223]
    v_exp_f32 v82, v82
    v_fma_f32 v85, v85, s40, v30
    v_exp_f32 v83, v83
    v_fma_f32 v86, v86, s40, v30
    v_exp_f32 v84, v84
    v_fma_f32 v87, v87, s40, v30
    v_exp_f32 v85, v85
    v_fma_f32 v88, v88, s40, v30
    v_exp_f32 v86, v86
    v_fma_f32 v89, v89, s40, v30
    v_exp_f32 v87, v87
    v_fma_f32 v90, v90, s40, v30
    v_exp_f32 v88, v88
    ds_read_b128 v[180:183], v17 offset:40960
    s_waitcnt lgkmcnt(3)
    v_mfma_f32_32x32x16_bf16 v[208:223], v[184:187], v[56:59], v[208:223]
    v_fma_f32 v91, v91, s40, v30
    v_exp_f32 v89, v89
    v_fma_f32 v92, v92, s40, v30
    v_exp_f32 v90, v90
    v_fma_f32 v93, v93, s40, v30
    v_exp_f32 v91, v91
    v_fma_f32 v94, v94, s40, v30
    v_exp_f32 v92, v92
    v_fma_f32 v95, v95, s40, v30
    v_exp_f32 v93, v93
    v_exp_f32 v94, v94
    v_exp_f32 v95, v95
    v_mul_f32 v29, v29, v13
    ds_read_b128 v[184:187], v18 offset:40960
    s_waitcnt lgkmcnt(3)
    v_mfma_f32_32x32x16_bf16 v[208:223], v[188:191], v[60:63], v[208:223]
    v_mul_f32 v96, v96, v13
    v_mul_f32 v97, v97, v13
    v_mul_f32 v98, v98, v13
    v_mul_f32 v99, v99, v13
    v_mul_f32 v100, v100, v13
    v_mul_f32 v101, v101, v13
    v_mul_f32 v102, v102, v13
    v_mul_f32 v103, v103, v13
    v_mul_f32 v104, v104, v13
    v_mul_f32 v105, v105, v13
    v_mul_f32 v106, v106, v13
    v_mul_f32 v107, v107, v13
    v_mul_f32 v108, v108, v13
    ds_read_b128 v[188:191], v19 offset:40960
    s_waitcnt lgkmcnt(3)
    v_mfma_f32_32x32x16_bf16 v[224:239], v[176:179], v[32:35], 0
    v_mul_f32 v109, v109, v13
    v_mul_f32 v110, v110, v13
    v_mul_f32 v111, v111, v13
    v_mul_f32 v112, v112, v13
    v_mul_f32 v113, v113, v13
    v_mul_f32 v114, v114, v13
    v_mul_f32 v115, v115, v13
    v_mul_f32 v116, v116, v13
    v_mul_f32 v117, v117, v13
    v_mul_f32 v118, v118, v13
    v_mul_f32 v119, v119, v13
    v_mul_f32 v120, v120, v13
    v_mul_f32 v121, v121, v13
    ds_read_b128 v[176:179], v20 offset:40960
    s_waitcnt lgkmcnt(3)
    v_mfma_f32_32x32x16_bf16 v[224:239], v[180:183], v[36:39], v[224:239]
    v_mul_f32 v122, v122, v13
    v_mul_f32 v123, v123, v13
    v_mul_f32 v124, v124, v13
    v_mul_f32 v125, v125, v13
    v_mul_f32 v126, v126, v13
    v_mul_f32 v127, v127, v13
    v_mul_f32 v128, v128, v13
    v_mul_f32 v129, v129, v13
    v_mul_f32 v130, v130, v13
    v_mul_f32 v131, v131, v13
    v_mul_f32 v132, v132, v13
    v_mul_f32 v133, v133, v13
    v_mul_f32 v134, v134, v13
    ds_read_b128 v[180:183], v21 offset:40960
    s_waitcnt lgkmcnt(3)
    v_mfma_f32_32x32x16_bf16 v[224:239], v[184:187], v[40:43], v[224:239]
    v_mul_f32 v135, v135, v13
    v_mul_f32 v136, v136, v13
    v_mul_f32 v137, v137, v13
    v_mul_f32 v138, v138, v13
    v_mul_f32 v139, v139, v13
    v_mul_f32 v140, v140, v13
    v_mul_f32 v141, v141, v13
    v_mul_f32 v142, v142, v13
    v_mul_f32 v143, v143, v13
    v_mul_f32 v144, v144, v13
    v_mul_f32 v145, v145, v13
    v_mul_f32 v146, v146, v13
    v_mul_f32 v147, v147, v13
    ds_read_b128 v[184:187], v22 offset:40960
    s_waitcnt lgkmcnt(3)
    v_mfma_f32_32x32x16_bf16 v[224:239], v[188:191], v[44:47], v[224:239]
    v_mul_f32 v148, v148, v13
    v_mul_f32 v149, v149, v13
    v_mul_f32 v150, v150, v13
    v_mul_f32 v151, v151, v13
    v_mul_f32 v152, v152, v13
    v_mul_f32 v153, v153, v13
    v_mul_f32 v154, v154, v13
    v_mul_f32 v155, v155, v13
    v_mul_f32 v156, v156, v13
    v_mul_f32 v157, v157, v13
    v_mul_f32 v158, v158, v13
    v_mul_f32 v159, v159, v13
    v_add_f32 v29, v29, v64
    ds_read_b128 v[188:191], v23 offset:40960
    s_waitcnt lgkmcnt(3)
    v_mfma_f32_32x32x16_bf16 v[224:239], v[176:179], v[48:51], v[224:239]
    v_add_f32 v29, v29, v65
    v_add_f32 v29, v29, v66
    v_add_f32 v29, v29, v67
    v_add_f32 v29, v29, v68
    v_add_f32 v29, v29, v69
    v_add_f32 v29, v29, v70
    v_add_f32 v29, v29, v71
    v_add_f32 v29, v29, v72
    v_add_f32 v29, v29, v73
    v_add_f32 v29, v29, v74
    v_add_f32 v29, v29, v75
    v_add_f32 v29, v29, v76
    v_add_f32 v29, v29, v77
    s_waitcnt lgkmcnt(2)
    v_mfma_f32_32x32x16_bf16 v[224:239], v[180:183], v[52:55], v[224:239]
    v_add_f32 v29, v29, v78
    v_add_f32 v29, v29, v79
    v_add_f32 v29, v29, v80
    v_add_f32 v29, v29, v81
    v_add_f32 v29, v29, v82
    v_add_f32 v29, v29, v83
    v_add_f32 v29, v29, v84
    v_add_f32 v29, v29, v85
    v_add_f32 v29, v29, v86
    v_add_f32 v29, v29, v87
    v_add_f32 v29, v29, v88
    v_add_f32 v29, v29, v89
    v_add_f32 v29, v29, v90
    s_waitcnt lgkmcnt(1)
    v_mfma_f32_32x32x16_bf16 v[224:239], v[184:187], v[56:59], v[224:239]
    v_add_f32 v29, v29, v91
    v_add_f32 v29, v29, v92
    v_add_f32 v29, v29, v93
    v_add_f32 v29, v29, v94
    v_add_f32 v29, v29, v95
    v_cvt_pk_bf16_f32 v160, v64, v65
    v_cvt_pk_bf16_f32 v161, v66, v67
    v_cvt_pk_bf16_f32 v162, v68, v69
    v_cvt_pk_bf16_f32 v163, v70, v71
    v_cvt_pk_bf16_f32 v164, v72, v73
    v_cvt_pk_bf16_f32 v165, v74, v75
    v_cvt_pk_bf16_f32 v166, v76, v77
    v_cvt_pk_bf16_f32 v167, v78, v79
    s_waitcnt lgkmcnt(0)
    v_mfma_f32_32x32x16_bf16 v[224:239], v[188:191], v[60:63], v[224:239]
    v_cvt_pk_bf16_f32 v168, v80, v81
    v_cvt_pk_bf16_f32 v169, v82, v83
    v_cvt_pk_bf16_f32 v170, v84, v85
    v_cvt_pk_bf16_f32 v171, v86, v87
    v_cvt_pk_bf16_f32 v172, v88, v89
    v_cvt_pk_bf16_f32 v173, v90, v91
    v_cvt_pk_bf16_f32 v174, v92, v93
    v_cvt_pk_bf16_f32 v175, v94, v95
    ds_read_b64_tr_b16 v[192:193], v24 offset:0
    ds_read_b64_tr_b16 v[194:195], v24 offset:2048
    ds_read_b64_tr_b16 v[196:197], v25 offset:0
    ds_read_b64_tr_b16 v[198:199], v25 offset:2048
    ds_read_b64_tr_b16 v[200:201], v26 offset:0
    ds_read_b64_tr_b16 v[202:203], v26 offset:2048
    ds_read_b64_tr_b16 v[204:205], v27 offset:0
    ds_read_b64_tr_b16 v[206:207], v27 offset:2048
    s_waitcnt lgkmcnt(6)
    v_mfma_f32_32x32x16_bf16 v[96:111], v[192:195], v[160:163], v[96:111]
    ds_read_b64_tr_b16 v[192:193], v24 offset:4096
    ds_read_b64_tr_b16 v[194:195], v24 offset:6144
    s_waitcnt lgkmcnt(6)
    v_mfma_f32_32x32x16_bf16 v[112:127], v[196:199], v[160:163], v[112:127]
    ds_read_b64_tr_b16 v[196:197], v25 offset:4096
    ds_read_b64_tr_b16 v[198:199], v25 offset:6144
    s_waitcnt lgkmcnt(6)
    v_mfma_f32_32x32x16_bf16 v[128:143], v[200:203], v[160:163], v[128:143]
    ds_read_b64_tr_b16 v[200:201], v26 offset:4096
    ds_read_b64_tr_b16 v[202:203], v26 offset:6144
    s_waitcnt lgkmcnt(6)
    v_mfma_f32_32x32x16_bf16 v[144:159], v[204:207], v[160:163], v[144:159]
    ds_read_b64_tr_b16 v[204:205], v27 offset:4096
    ds_read_b64_tr_b16 v[206:207], v27 offset:6144
    s_waitcnt lgkmcnt(6)
    v_mfma_f32_32x32x16_bf16 v[96:111], v[192:195], v[164:167], v[96:111]
    ds_read_b64_tr_b16 v[192:193], v24 offset:8192
    ds_read_b64_tr_b16 v[194:195], v24 offset:10240
    s_waitcnt lgkmcnt(6)
    v_mfma_f32_32x32x16_bf16 v[112:127], v[196:199], v[164:167], v[112:127]
    ds_read_b64_tr_b16 v[196:197], v25 offset:8192
    ds_read_b64_tr_b16 v[198:199], v25 offset:10240
    s_waitcnt lgkmcnt(6)
    v_mfma_f32_32x32x16_bf16 v[128:143], v[200:203], v[164:167], v[128:143]
    ds_read_b64_tr_b16 v[200:201], v26 offset:8192
    ds_read_b64_tr_b16 v[202:203], v26 offset:10240
    s_waitcnt lgkmcnt(6)
    v_mfma_f32_32x32x16_bf16 v[144:159], v[204:207], v[164:167], v[144:159]
    ds_read_b64_tr_b16 v[204:205], v27 offset:8192
    ds_read_b64_tr_b16 v[206:207], v27 offset:10240
    s_waitcnt lgkmcnt(6)
    v_mfma_f32_32x32x16_bf16 v[96:111], v[192:195], v[168:171], v[96:111]
    ds_read_b64_tr_b16 v[192:193], v24 offset:12288
    ds_read_b64_tr_b16 v[194:195], v24 offset:14336
    s_waitcnt lgkmcnt(6)
    v_mfma_f32_32x32x16_bf16 v[112:127], v[196:199], v[168:171], v[112:127]
    ds_read_b64_tr_b16 v[196:197], v25 offset:12288
    ds_read_b64_tr_b16 v[198:199], v25 offset:14336
    s_waitcnt lgkmcnt(6)
    v_mfma_f32_32x32x16_bf16 v[128:143], v[200:203], v[168:171], v[128:143]
    ds_read_b64_tr_b16 v[200:201], v26 offset:12288
    ds_read_b64_tr_b16 v[202:203], v26 offset:14336
    s_waitcnt lgkmcnt(6)
    v_mfma_f32_32x32x16_bf16 v[144:159], v[204:207], v[168:171], v[144:159]
    ds_read_b64_tr_b16 v[204:205], v27 offset:12288
    ds_read_b64_tr_b16 v[206:207], v27 offset:14336
    s_waitcnt lgkmcnt(6)
    v_mfma_f32_32x32x16_bf16 v[96:111], v[192:195], v[172:175], v[96:111]
    s_waitcnt lgkmcnt(4)
    v_mfma_f32_32x32x16_bf16 v[112:127], v[196:199], v[172:175], v[112:127]
    s_waitcnt lgkmcnt(2)
    v_mfma_f32_32x32x16_bf16 v[128:143], v[200:203], v[172:175], v[128:143]
    s_waitcnt lgkmcnt(0)
    v_mfma_f32_32x32x16_bf16 v[144:159], v[204:207], v[172:175], v[144:159]
    s_waitcnt vmcnt(0)
    s_barrier
    s_lshl_b32 s36, s35, 12
    s_add_u32 m0, s36, 32768
    s_add_u32 s36, s41, 0
    buffer_load_dwordx4 v8, s[8:11], s36 offen lds
    s_lshl_b32 s36, s35, 12
    s_add_u32 m0, s36, 33792
    s_add_u32 s36, s41, 1024
    buffer_load_dwordx4 v9, s[8:11], s36 offen lds
    s_lshl_b32 s36, s35, 12
    s_add_u32 m0, s36, 34816
    s_add_u32 s36, s41, 2048
    buffer_load_dwordx4 v10, s[8:11], s36 offen lds
    s_lshl_b32 s36, s35, 12
    s_add_u32 m0, s36, 35840
    s_add_u32 s36, s41, 3072
    buffer_load_dwordx4 v11, s[8:11], s36 offen lds
    s_add_u32 s41, s41, 16384
    s_lshl_b32 s36, s35, 12
    s_add_u32 m0, s36, 16384
    s_add_u32 s36, s43, 0
    buffer_load_dwordx4 v12, s[12:15], s36 offen lds
    s_lshl_b32 s36, s35, 12
    s_add_u32 m0, s36, 17408
    s_add_u32 s36, s43, 1024
    buffer_load_dwordx4 v12, s[12:15], s36 offen lds
    s_lshl_b32 s36, s35, 12
    s_add_u32 m0, s36, 18432
    s_add_u32 s36, s43, 2048
    buffer_load_dwordx4 v12, s[12:15], s36 offen lds
    s_lshl_b32 s36, s35, 12
    s_add_u32 m0, s36, 19456
    s_add_u32 s36, s43, 3072
    buffer_load_dwordx4 v12, s[12:15], s36 offen lds
    s_add_u32 s43, s43, 16384
    ds_read_b128 v[176:179], v16 offset:0
    ds_read_b128 v[180:183], v17 offset:0
    ds_read_b128 v[184:187], v18 offset:0
    ds_read_b128 v[188:191], v19 offset:0
    s_waitcnt lgkmcnt(3)
    v_mfma_f32_32x32x16_bf16 v[64:79], v[176:179], v[32:35], 0
    v_max3_f32 v30, v208, v209, v210
    v_max3_f32 v30, v30, v211, v212
    v_max3_f32 v30, v30, v213, v214
    v_max3_f32 v30, v30, v215, v216
    v_max3_f32 v30, v30, v217, v218
    v_max3_f32 v30, v30, v219, v220
    v_max3_f32 v30, v30, v221, v222
    v_max3_f32 v30, v30, v223, v224
    v_max3_f32 v30, v30, v225, v226
    v_max3_f32 v30, v30, v227, v228
    v_max3_f32 v30, v30, v229, v230
    v_max3_f32 v30, v30, v231, v232
    v_max3_f32 v30, v30, v233, v234
    ds_read_b128 v[176:179], v20 offset:0
    s_waitcnt lgkmcnt(3)
    v_mfma_f32_32x32x16_bf16 v[64:79], v[180:183], v[36:39], v[64:79]
    v_max3_f32 v30, v30, v235, v236
    v_max3_f32 v30, v30, v237, v238
    v_max_f32 v30, v30, v239
    v_mov_b32 v31, v30
    s_nop 1
    v_permlane32_swap_b32 v30, v31
    v_max_f32 v30, v30, v31
    v_mul_f32 v30, s40, v30
    v_max_f32 v30, v30, v28
    v_sub_f32 v13, v28, v30
    v_exp_f32 v13, v13
    v_mov_b32 v28, v30
    v_mul_f32 v30, -1.0, v30
    ds_read_b128 v[180:183], v21 offset:0
    s_waitcnt lgkmcnt(3)
    v_mfma_f32_32x32x16_bf16 v[64:79], v[184:187], v[40:43], v[64:79]
    v_fma_f32 v208, v208, s40, v30
    v_fma_f32 v209, v209, s40, v30
    v_fma_f32 v210, v210, s40, v30
    v_exp_f32 v208, v208
    v_fma_f32 v211, v211, s40, v30
    v_exp_f32 v209, v209
    v_fma_f32 v212, v212, s40, v30
    v_exp_f32 v210, v210
    v_fma_f32 v213, v213, s40, v30
    v_exp_f32 v211, v211
    v_fma_f32 v214, v214, s40, v30
    v_exp_f32 v212, v212
    v_fma_f32 v215, v215, s40, v30
    ds_read_b128 v[184:187], v22 offset:0
    s_waitcnt lgkmcnt(3)
    v_mfma_f32_32x32x16_bf16 v[64:79], v[188:191], v[44:47], v[64:79]
    v_exp_f32 v213, v213
    v_fma_f32 v216, v216, s40, v30
    v_exp_f32 v214, v214
    v_fma_f32 v217, v217, s40, v30
    v_exp_f32 v215, v215
    v_fma_f32 v218, v218, s40, v30
    v_exp_f32 v216, v216
    v_fma_f32 v219, v219, s40, v30
    v_exp_f32 v217, v217
    v_fma_f32 v220, v220, s40, v30
    v_exp_f32 v218, v218
    v_fma_f32 v221, v221, s40, v30
    v_exp_f32 v219, v219
    ds_read_b128 v[188:191], v23 offset:0
    s_waitcnt lgkmcnt(3)
    v_mfma_f32_32x32x16_bf16 v[64:79], v[176:179], v[48:51], v[64:79]
    v_fma_f32 v222, v222, s40, v30
    v_exp_f32 v220, v220
    v_fma_f32 v223, v223, s40, v30
    v_exp_f32 v221, v221
    v_fma_f32 v224, v224, s40, v30
    v_exp_f32 v222, v222
    v_fma_f32 v225, v225, s40, v30
    v_exp_f32 v223, v223
    v_fma_f32 v226, v226, s40, v30
    v_exp_f32 v224, v224
    v_fma_f32 v227, v227, s40, v30
    v_exp_f32 v225, v225
    v_fma_f32 v228, v228, s40, v30
    ds_read_b128 v[176:179], v16 offset:8192
    s_waitcnt lgkmcnt(3)
    v_mfma_f32_32x32x16_bf16 v[64:79], v[180:183], v[52:55], v[64:79]
    v_exp_f32 v226, v226
    v_fma_f32 v229, v229, s40, v30
    v_exp_f32 v227, v227
    v_fma_f32 v230, v230, s40, v30
    v_exp_f32 v228, v228
    v_fma_f32 v231, v231, s40, v30
    v_exp_f32 v229, v229
    v_fma_f32 v232, v232, s40, v30
    v_exp_f32 v230, v230
    v_fma_f32 v233, v233, s40, v30
    v_exp_f32 v231, v231
    v_fma_f32 v234, v234, s40, v30
    v_exp_f32 v232, v232
    ds_read_b128 v[180:183], v17 offset:8192
    s_waitcnt lgkmcnt(3)
    v_mfma_f32_32x32x16_bf16 v[64:79], v[184:187], v[56:59], v[64:79]
    v_fma_f32 v235, v235, s40, v30
    v_exp_f32 v233, v233
    v_fma_f32 v236, v236, s40, v30
    v_exp_f32 v234, v234
    v_fma_f32 v237, v237, s40, v30
    v_exp_f32 v235, v235
    v_fma_f32 v238, v238, s40, v30
    v_exp_f32 v236, v236
    v_fma_f32 v239, v239, s40, v30
    v_exp_f32 v237, v237
    v_exp_f32 v238, v238
    v_exp_f32 v239, v239
    v_mul_f32 v29, v29, v13
    ds_read_b128 v[184:187], v18 offset:8192
    s_waitcnt lgkmcnt(3)
    v_mfma_f32_32x32x16_bf16 v[64:79], v[188:191], v[60:63], v[64:79]
    v_mul_f32 v96, v96, v13
    v_mul_f32 v97, v97, v13
    v_mul_f32 v98, v98, v13
    v_mul_f32 v99, v99, v13
    v_mul_f32 v100, v100, v13
    v_mul_f32 v101, v101, v13
    v_mul_f32 v102, v102, v13
    v_mul_f32 v103, v103, v13
    v_mul_f32 v104, v104, v13
    v_mul_f32 v105, v105, v13
    v_mul_f32 v106, v106, v13
    v_mul_f32 v107, v107, v13
    v_mul_f32 v108, v108, v13
    ds_read_b128 v[188:191], v19 offset:8192
    s_waitcnt lgkmcnt(3)
    v_mfma_f32_32x32x16_bf16 v[80:95], v[176:179], v[32:35], 0
    v_mul_f32 v109, v109, v13
    v_mul_f32 v110, v110, v13
    v_mul_f32 v111, v111, v13
    v_mul_f32 v112, v112, v13
    v_mul_f32 v113, v113, v13
    v_mul_f32 v114, v114, v13
    v_mul_f32 v115, v115, v13
    v_mul_f32 v116, v116, v13
    v_mul_f32 v117, v117, v13
    v_mul_f32 v118, v118, v13
    v_mul_f32 v119, v119, v13
    v_mul_f32 v120, v120, v13
    v_mul_f32 v121, v121, v13
    ds_read_b128 v[176:179], v20 offset:8192
    s_waitcnt lgkmcnt(3)
    v_mfma_f32_32x32x16_bf16 v[80:95], v[180:183], v[36:39], v[80:95]
    v_mul_f32 v122, v122, v13
    v_mul_f32 v123, v123, v13
    v_mul_f32 v124, v124, v13
    v_mul_f32 v125, v125, v13
    v_mul_f32 v126, v126, v13
    v_mul_f32 v127, v127, v13
    v_mul_f32 v128, v128, v13
    v_mul_f32 v129, v129, v13
    v_mul_f32 v130, v130, v13
    v_mul_f32 v131, v131, v13
    v_mul_f32 v132, v132, v13
    v_mul_f32 v133, v133, v13
    v_mul_f32 v134, v134, v13
    ds_read_b128 v[180:183], v21 offset:8192
    s_waitcnt lgkmcnt(3)
    v_mfma_f32_32x32x16_bf16 v[80:95], v[184:187], v[40:43], v[80:95]
    v_mul_f32 v135, v135, v13
    v_mul_f32 v136, v136, v13
    v_mul_f32 v137, v137, v13
    v_mul_f32 v138, v138, v13
    v_mul_f32 v139, v139, v13
    v_mul_f32 v140, v140, v13
    v_mul_f32 v141, v141, v13
    v_mul_f32 v142, v142, v13
    v_mul_f32 v143, v143, v13
    v_mul_f32 v144, v144, v13
    v_mul_f32 v145, v145, v13
    v_mul_f32 v146, v146, v13
    v_mul_f32 v147, v147, v13
    ds_read_b128 v[184:187], v22 offset:8192
    s_waitcnt lgkmcnt(3)
    v_mfma_f32_32x32x16_bf16 v[80:95], v[188:191], v[44:47], v[80:95]
    v_mul_f32 v148, v148, v13
    v_mul_f32 v149, v149, v13
    v_mul_f32 v150, v150, v13
    v_mul_f32 v151, v151, v13
    v_mul_f32 v152, v152, v13
    v_mul_f32 v153, v153, v13
    v_mul_f32 v154, v154, v13
    v_mul_f32 v155, v155, v13
    v_mul_f32 v156, v156, v13
    v_mul_f32 v157, v157, v13
    v_mul_f32 v158, v158, v13
    v_mul_f32 v159, v159, v13
    v_add_f32 v29, v29, v208
    ds_read_b128 v[188:191], v23 offset:8192
    s_waitcnt lgkmcnt(3)
    v_mfma_f32_32x32x16_bf16 v[80:95], v[176:179], v[48:51], v[80:95]
    v_add_f32 v29, v29, v209
    v_add_f32 v29, v29, v210
    v_add_f32 v29, v29, v211
    v_add_f32 v29, v29, v212
    v_add_f32 v29, v29, v213
    v_add_f32 v29, v29, v214
    v_add_f32 v29, v29, v215
    v_add_f32 v29, v29, v216
    v_add_f32 v29, v29, v217
    v_add_f32 v29, v29, v218
    v_add_f32 v29, v29, v219
    v_add_f32 v29, v29, v220
    v_add_f32 v29, v29, v221
    s_waitcnt lgkmcnt(2)
    v_mfma_f32_32x32x16_bf16 v[80:95], v[180:183], v[52:55], v[80:95]
    v_add_f32 v29, v29, v222
    v_add_f32 v29, v29, v223
    v_add_f32 v29, v29, v224
    v_add_f32 v29, v29, v225
    v_add_f32 v29, v29, v226
    v_add_f32 v29, v29, v227
    v_add_f32 v29, v29, v228
    v_add_f32 v29, v29, v229
    v_add_f32 v29, v29, v230
    v_add_f32 v29, v29, v231
    v_add_f32 v29, v29, v232
    v_add_f32 v29, v29, v233
    v_add_f32 v29, v29, v234
    s_waitcnt lgkmcnt(1)
    v_mfma_f32_32x32x16_bf16 v[80:95], v[184:187], v[56:59], v[80:95]
    v_add_f32 v29, v29, v235
    v_add_f32 v29, v29, v236
    v_add_f32 v29, v29, v237
    v_add_f32 v29, v29, v238
    v_add_f32 v29, v29, v239
    v_cvt_pk_bf16_f32 v160, v208, v209
    v_cvt_pk_bf16_f32 v161, v210, v211
    v_cvt_pk_bf16_f32 v162, v212, v213
    v_cvt_pk_bf16_f32 v163, v214, v215
    v_cvt_pk_bf16_f32 v164, v216, v217
    v_cvt_pk_bf16_f32 v165, v218, v219
    v_cvt_pk_bf16_f32 v166, v220, v221
    v_cvt_pk_bf16_f32 v167, v222, v223
    s_waitcnt lgkmcnt(0)
    v_mfma_f32_32x32x16_bf16 v[80:95], v[188:191], v[60:63], v[80:95]
    v_cvt_pk_bf16_f32 v168, v224, v225
    v_cvt_pk_bf16_f32 v169, v226, v227
    v_cvt_pk_bf16_f32 v170, v228, v229
    v_cvt_pk_bf16_f32 v171, v230, v231
    v_cvt_pk_bf16_f32 v172, v232, v233
    v_cvt_pk_bf16_f32 v173, v234, v235
    v_cvt_pk_bf16_f32 v174, v236, v237
    v_cvt_pk_bf16_f32 v175, v238, v239
    ds_read_b64_tr_b16 v[192:193], v24 offset:32768
    ds_read_b64_tr_b16 v[194:195], v24 offset:34816
    ds_read_b64_tr_b16 v[196:197], v25 offset:32768
    ds_read_b64_tr_b16 v[198:199], v25 offset:34816
    ds_read_b64_tr_b16 v[200:201], v26 offset:32768
    ds_read_b64_tr_b16 v[202:203], v26 offset:34816
    ds_read_b64_tr_b16 v[204:205], v27 offset:32768
    ds_read_b64_tr_b16 v[206:207], v27 offset:34816
    s_waitcnt lgkmcnt(6)
    v_mfma_f32_32x32x16_bf16 v[96:111], v[192:195], v[160:163], v[96:111]
    ds_read_b64_tr_b16 v[192:193], v24 offset:36864
    ds_read_b64_tr_b16 v[194:195], v24 offset:38912
    s_waitcnt lgkmcnt(6)
    v_mfma_f32_32x32x16_bf16 v[112:127], v[196:199], v[160:163], v[112:127]
    ds_read_b64_tr_b16 v[196:197], v25 offset:36864
    ds_read_b64_tr_b16 v[198:199], v25 offset:38912
    s_waitcnt lgkmcnt(6)
    v_mfma_f32_32x32x16_bf16 v[128:143], v[200:203], v[160:163], v[128:143]
    ds_read_b64_tr_b16 v[200:201], v26 offset:36864
    ds_read_b64_tr_b16 v[202:203], v26 offset:38912
    s_waitcnt lgkmcnt(6)
    v_mfma_f32_32x32x16_bf16 v[144:159], v[204:207], v[160:163], v[144:159]
    ds_read_b64_tr_b16 v[204:205], v27 offset:36864
    ds_read_b64_tr_b16 v[206:207], v27 offset:38912
    s_waitcnt lgkmcnt(6)
    v_mfma_f32_32x32x16_bf16 v[96:111], v[192:195], v[164:167], v[96:111]
    ds_read_b64_tr_b16 v[192:193], v24 offset:40960
    ds_read_b64_tr_b16 v[194:195], v24 offset:43008
    s_waitcnt lgkmcnt(6)
    v_mfma_f32_32x32x16_bf16 v[112:127], v[196:199], v[164:167], v[112:127]
    ds_read_b64_tr_b16 v[196:197], v25 offset:40960
    ds_read_b64_tr_b16 v[198:199], v25 offset:43008
    s_waitcnt lgkmcnt(6)
    v_mfma_f32_32x32x16_bf16 v[128:143], v[200:203], v[164:167], v[128:143]
    ds_read_b64_tr_b16 v[200:201], v26 offset:40960
    ds_read_b64_tr_b16 v[202:203], v26 offset:43008
    s_waitcnt lgkmcnt(6)
    v_mfma_f32_32x32x16_bf16 v[144:159], v[204:207], v[164:167], v[144:159]
    ds_read_b64_tr_b16 v[204:205], v27 offset:40960
    ds_read_b64_tr_b16 v[206:207], v27 offset:43008
    s_waitcnt lgkmcnt(6)
    v_mfma_f32_32x32x16_bf16 v[96:111], v[192:195], v[168:171], v[96:111]
    ds_read_b64_tr_b16 v[192:193], v24 offset:45056
    ds_read_b64_tr_b16 v[194:195], v24 offset:47104
    s_waitcnt lgkmcnt(6)
    v_mfma_f32_32x32x16_bf16 v[112:127], v[196:199], v[168:171], v[112:127]
    ds_read_b64_tr_b16 v[196:197], v25 offset:45056
    ds_read_b64_tr_b16 v[198:199], v25 offset:47104
    s_waitcnt lgkmcnt(6)
    v_mfma_f32_32x32x16_bf16 v[128:143], v[200:203], v[168:171], v[128:143]
    ds_read_b64_tr_b16 v[200:201], v26 offset:45056
    ds_read_b64_tr_b16 v[202:203], v26 offset:47104
    s_waitcnt lgkmcnt(6)
    v_mfma_f32_32x32x16_bf16 v[144:159], v[204:207], v[168:171], v[144:159]
    ds_read_b64_tr_b16 v[204:205], v27 offset:45056
    ds_read_b64_tr_b16 v[206:207], v27 offset:47104
    s_waitcnt lgkmcnt(6)
    v_mfma_f32_32x32x16_bf16 v[96:111], v[192:195], v[172:175], v[96:111]
    s_waitcnt lgkmcnt(4)
    v_mfma_f32_32x32x16_bf16 v[112:127], v[196:199], v[172:175], v[112:127]
    s_waitcnt lgkmcnt(2)
    v_mfma_f32_32x32x16_bf16 v[128:143], v[200:203], v[172:175], v[128:143]
    s_waitcnt lgkmcnt(0)
    v_mfma_f32_32x32x16_bf16 v[144:159], v[204:207], v[172:175], v[144:159]
    s_sub_u32 s42, s42, 1
    s_cmp_lg_u32 s42, 0
    s_cbranch_scc1 attn_loop2
    s_nop 15
    s_nop 7
    v_mov_b32 v30, v29
    s_nop 1
    v_permlane32_swap_b32 v29, v30
    v_add_f32 v29, v29, v30
    v_rcp_f32 v29, v29
    s_nop 0
    v_lshlrev_b32 v7, 3, v4
    v_add_u32 v7, v6, v7
    v_mul_f32 v96, v96, v29
    v_mul_f32 v97, v97, v29
    v_mul_f32 v98, v98, v29
    v_mul_f32 v99, v99, v29
    v_cvt_pk_bf16_f32 v96, v96, v97
    v_cvt_pk_bf16_f32 v97, v98, v99
    buffer_store_dwordx2 v[96:97], v7, s[20:23], 0 offen offset:0
    v_mul_f32 v100, v100, v29
    v_mul_f32 v101, v101, v29
    v_mul_f32 v102, v102, v29
    v_mul_f32 v103, v103, v29
    v_cvt_pk_bf16_f32 v100, v100, v101
    v_cvt_pk_bf16_f32 v101, v102, v103
    buffer_store_dwordx2 v[100:101], v7, s[20:23], 0 offen offset:16
    v_mul_f32 v104, v104, v29
    v_mul_f32 v105, v105, v29
    v_mul_f32 v106, v106, v29
    v_mul_f32 v107, v107, v29
    v_cvt_pk_bf16_f32 v104, v104, v105
    v_cvt_pk_bf16_f32 v105, v106, v107
    buffer_store_dwordx2 v[104:105], v7, s[20:23], 0 offen offset:32
    v_mul_f32 v108, v108, v29
    v_mul_f32 v109, v109, v29
    v_mul_f32 v110, v110, v29
    v_mul_f32 v111, v111, v29
    v_cvt_pk_bf16_f32 v108, v108, v109
    v_cvt_pk_bf16_f32 v109, v110, v111
    buffer_store_dwordx2 v[108:109], v7, s[20:23], 0 offen offset:48
    v_mul_f32 v112, v112, v29
    v_mul_f32 v113, v113, v29
    v_mul_f32 v114, v114, v29
    v_mul_f32 v115, v115, v29
    v_cvt_pk_bf16_f32 v112, v112, v113
    v_cvt_pk_bf16_f32 v113, v114, v115
    buffer_store_dwordx2 v[112:113], v7, s[20:23], 0 offen offset:64
    v_mul_f32 v116, v116, v29
    v_mul_f32 v117, v117, v29
    v_mul_f32 v118, v118, v29
    v_mul_f32 v119, v119, v29
    v_cvt_pk_bf16_f32 v116, v116, v117
    v_cvt_pk_bf16_f32 v117, v118, v119
    buffer_store_dwordx2 v[116:117], v7, s[20:23], 0 offen offset:80
    v_mul_f32 v120, v120, v29
    v_mul_f32 v121, v121, v29
    v_mul_f32 v122, v122, v29
    v_mul_f32 v123, v123, v29
    v_cvt_pk_bf16_f32 v120, v120, v121
    v_cvt_pk_bf16_f32 v121, v122, v123
    buffer_store_dwordx2 v[120:121], v7, s[20:23], 0 offen offset:96
    v_mul_f32 v124, v124, v29
    v_mul_f32 v125, v125, v29
    v_mul_f32 v126, v126, v29
    v_mul_f32 v127, v127, v29
    v_cvt_pk_bf16_f32 v124, v124, v125
    v_cvt_pk_bf16_f32 v125, v126, v127
    buffer_store_dwordx2 v[124:125], v7, s[20:23], 0 offen offset:112
    v_mul_f32 v128, v128, v29
    v_mul_f32 v129, v129, v29
    v_mul_f32 v130, v130, v29
    v_mul_f32 v131, v131, v29
    v_cvt_pk_bf16_f32 v128, v128, v129
    v_cvt_pk_bf16_f32 v129, v130, v131
    buffer_store_dwordx2 v[128:129], v7, s[20:23], 0 offen offset:128
    v_mul_f32 v132, v132, v29
    v_mul_f32 v133, v133, v29
    v_mul_f32 v134, v134, v29
    v_mul_f32 v135, v135, v29
    v_cvt_pk_bf16_f32 v132, v132, v133
    v_cvt_pk_bf16_f32 v133, v134, v135
    buffer_store_dwordx2 v[132:133], v7, s[20:23], 0 offen offset:144
    v_mul_f32 v136, v136, v29
    v_mul_f32 v137, v137, v29
    v_mul_f32 v138, v138, v29
    v_mul_f32 v139, v139, v29
    v_cvt_pk_bf16_f32 v136, v136, v137
    v_cvt_pk_bf16_f32 v137, v138, v139
    buffer_store_dwordx2 v[136:137], v7, s[20:23], 0 offen offset:160
    v_mul_f32 v140, v140, v29
    v_mul_f32 v141, v141, v29
    v_mul_f32 v142, v142, v29
    v_mul_f32 v143, v143, v29
    v_cvt_pk_bf16_f32 v140, v140, v141
    v_cvt_pk_bf16_f32 v141, v142, v143
    buffer_store_dwordx2 v[140:141], v7, s[20:23], 0 offen offset:176
    v_mul_f32 v144, v144, v29
    v_mul_f32 v145, v145, v29
    v_mul_f32 v146, v146, v29
    v_mul_f32 v147, v147, v29
    v_cvt_pk_bf16_f32 v144, v144, v145
    v_cvt_pk_bf16_f32 v145, v146, v147
    buffer_store_dwordx2 v[144:145], v7, s[20:23], 0 offen offset:192
    v_mul_f32 v148, v148, v29
    v_mul_f32 v149, v149, v29
    v_mul_f32 v150, v150, v29
    v_mul_f32 v151, v151, v29
    v_cvt_pk_bf16_f32 v148, v148, v149
    v_cvt_pk_bf16_f32 v149, v150, v151
    buffer_store_dwordx2 v[148:149], v7, s[20:23], 0 offen offset:208
    v_mul_f32 v152, v152, v29
    v_mul_f32 v153, v153, v29
    v_mul_f32 v154, v154, v29
    v_mul_f32 v155, v155, v29
    v_cvt_pk_bf16_f32 v152, v152, v153
    v_cvt_pk_bf16_f32 v153, v154, v155
    buffer_store_dwordx2 v[152:153], v7, s[20:23], 0 offen offset:224
    v_mul_f32 v156, v156, v29
    v_mul_f32 v157, v157, v29
    v_mul_f32 v158, v158, v29
    v_mul_f32 v159, v159, v29
    v_cvt_pk_bf16_f32 v156, v156, v157
    v_cvt_pk_bf16_f32 v157, v158, v159
    buffer_store_dwordx2 v[156:157], v7, s[20:23], 0 offen offset:240
attn_done1:
    s_endpgm
.globl wo_kernel
.p2align 8
.type wo_kernel,@function
wo_kernel:
    s_cmp_ge_u32 s2, 256
    s_cbranch_scc1 wo_done1
    s_load_dwordx2 s[28:29], s[0:1], 112
    s_load_dwordx2 s[40:41], s[0:1], 32
    s_waitcnt lgkmcnt(0)
    s_add_u32 s8, s28, 33554432
    s_addc_u32 s9, s29, 0
    s_and_b32 s9, s9, 0xffff
    s_mov_b32 s10, 16777216
    s_mov_b32 s11, 0x20000
    s_mov_b32 s12, s40
    s_mov_b32 s13, s41
    s_and_b32 s13, s13, 0xffff
    s_mov_b32 s14, 4194304
    s_mov_b32 s15, 0x20000
    s_add_u32 s16, s28, 75497472
    s_addc_u32 s17, s29, 0
    s_and_b32 s17, s17, 0xffff
    s_mov_b32 s18, 33554432
    s_mov_b32 s19, 0x20000
    s_and_b32 s39, s2, 3
    s_lshr_b32 s2, s2, 2
    s_mov_b32 s30, 1073741825
    s_mul_hi_u32 s31, s2, s30
    s_mul_i32 s32, s31, 4
    s_sub_u32 s32, s2, s32
    s_mul_i32 s33, s31, 128
    s_mul_i32 s34, s32, 128
    v_lshrrev_b32 v1, 6, v0
    v_and_b32 v2, 63, v0
    v_readfirstlane_b32 s35, v1
    s_nop 3
    v_lshrrev_b32 v6, 3, v2
    s_mul_i32 s36, s35, 32
    s_add_u32 s36, s36, s33
    v_add_u32 v6, s36, v6
    v_mul_u32_u24 v6, 8192, v6
    v_lshrrev_b32 v7, 4, v2
    v_and_b32 v8, 7, v2
    v_add_u32 v9, 0, v7
    v_and_b32 v9, 7, v9
    v_xor_b32 v9, v9, v8
    v_lshlrev_b32 v9, 4, v9
    v_add_u32 v3, v6, v9
    v_add_u32 v9, 4, v7
    v_and_b32 v9, 7, v9
    v_xor_b32 v9, v9, v8
    v_lshlrev_b32 v9, 4, v9
    v_add_u32 v4, v6, v9
    v_lshrrev_b32 v6, 4, v2
    v_and_b32 v8, 15, v2
    v_lshlrev_b32 v9, 2, v6
    v_xor_b32 v9, v9, v8
    s_mul_i32 s36, s35, 16
    v_add_u32 v6, s36, v6
    v_mul_u32_u24 v6, 1024, v6
    v_lshlrev_b32 v9, 4, v9
    v_add_u32 v6, v6, v9
    s_lshl_b32 s36, s34, 1
    v_add_u32 v5, s36, v6
    s_lshr_b32 s37, s35, 1
    s_and_b32 s38, s35, 1
    v_and_b32 v6, 31, v2
    v_lshrrev_b32 v7, 5, v2
    s_mul_i32 s36, s37, 64
    v_add_u32 v8, s36, v6
    v_lshrrev_b32 v9, 1, v8
    v_and_b32 v9, 7, v9
    v_xor_b32 v9, v9, v7
    v_lshlrev_b32 v9, 4, v9
    v_lshlrev_b32 v8, 7, v8
    v_add_u32 v10, v8, v9
    v_xor_b32 v11, 32, v10
    v_xor_b32 v12, 64, v10
    v_xor_b32 v13, 96, v10
    v_lshrrev_b32 v6, 4, v2
    v_and_b32 v7, 15, v2
    v_lshrrev_b32 v8, 1, v6
    v_lshlrev_b32 v8, 3, v8
    v_lshrrev_b32 v9, 2, v7
    v_add_u32 v8, v8, v9
    v_mul_u32_u24 v8, 256, v8
    v_and_b32 v6, 1, v6
    v_lshlrev_b32 v6, 1, v6
    v_and_b32 v16, 3, v7
    v_lshrrev_b32 v16, 1, v16
    v_add_u32 v6, v6, v16
    s_mul_i32 s36, s38, 8
    v_add_u32 v6, s36, v6
    v_lshlrev_b32 v9, 2, v9
    v_and_b32 v16, 1, v7
    v_lshlrev_b32 v16, 3, v16
    v_add_u32 v8, v8, v16
    v_add_u32 v16, 0, v6
    v_xor_b32 v16, v16, v9
    v_lshlrev_b32 v16, 4, v16
    v_add_u32 v14, v8, v16
    v_add_u32 v14, 16384, v14
    v_add_u32 v16, 4, v6
    v_xor_b32 v16, v16, v9
    v_lshlrev_b32 v16, 4, v16
    v_add_u32 v15, v8, v16
    v_add_u32 v15, 16384, v15
    v_add_u32 v20, 0x10000, v10
    v_add_u32 v21, 0x10000, v11
    v_add_u32 v22, 0x10000, v12
    v_add_u32 v23, 0x10000, v13
    v_add_u32 v24, 0x10000, v14
    v_add_u32 v25, 0x10000, v15
    v_mov_b32 v60, 0
    v_mov_b32 v61, 0
    v_mov_b32 v62, 0
    v_mov_b32 v63, 0
    v_mov_b32 v64, 0
    v_mov_b32 v65, 0
    v_mov_b32 v66, 0
    v_mov_b32 v67, 0
    v_mov_b32 v68, 0
    v_mov_b32 v69, 0
    v_mov_b32 v70, 0
    v_mov_b32 v71, 0
    v_mov_b32 v72, 0
    v_mov_b32 v73, 0
    v_mov_b32 v74, 0
    v_mov_b32 v75, 0
    v_mov_b32 v76, 0
    v_mov_b32 v77, 0
    v_mov_b32 v78, 0
    v_mov_b32 v79, 0
    v_mov_b32 v80, 0
    v_mov_b32 v81, 0
    v_mov_b32 v82, 0
    v_mov_b32 v83, 0
    v_mov_b32 v84, 0
    v_mov_b32 v85, 0
    v_mov_b32 v86, 0
    v_mov_b32 v87, 0
    v_mov_b32 v88, 0
    v_mov_b32 v89, 0
    v_mov_b32 v90, 0
    v_mov_b32 v91, 0
    v_mov_b32 v92, 0
    v_mov_b32 v93, 0
    v_mov_b32 v94, 0
    v_mov_b32 v95, 0
    v_mov_b32 v96, 0
    v_mov_b32 v97, 0
    v_mov_b32 v98, 0
    v_mov_b32 v99, 0
    v_mov_b32 v100, 0
    v_mov_b32 v101, 0
    v_mov_b32 v102, 0
    v_mov_b32 v103, 0
    v_mov_b32 v104, 0
    v_mov_b32 v105, 0
    v_mov_b32 v106, 0
    v_mov_b32 v107, 0
    v_mov_b32 v108, 0
    v_mov_b32 v109, 0
    v_mov_b32 v110, 0
    v_mov_b32 v111, 0
    v_mov_b32 v112, 0
    v_mov_b32 v113, 0
    v_mov_b32 v114, 0
    v_mov_b32 v115, 0
    v_mov_b32 v116, 0
    v_mov_b32 v117, 0
    v_mov_b32 v118, 0
    v_mov_b32 v119, 0
    v_mov_b32 v120, 0
    v_mov_b32 v121, 0
    v_mov_b32 v122, 0
    v_mov_b32 v123, 0
    s_mul_i32 s40, s39, 2048
    s_mul_i32 s41, s39, 1048576
    s_mul_i32 s36, s35, 4096
    s_add_u32 m0, s36, 0
    s_add_u32 s36, s40, 0
    buffer_load_dwordx4 v3, s[8:11], s36 offen lds
    s_mul_i32 s36, s35, 4096
    s_add_u32 m0, s36, 1024
    s_add_u32 s36, s40, 65536
    buffer_load_dwordx4 v4, s[8:11], s36 offen lds
    s_mul_i32 s36, s35, 4096
    s_add_u32 m0, s36, 2048
    s_add_u32 s36, s40, 131072
    buffer_load_dwordx4 v3, s[8:11], s36 offen lds
    s_mul_i32 s36, s35, 4096
    s_add_u32 m0, s36, 3072
    s_add_u32 s36, s40, 196608
    buffer_load_dwordx4 v4, s[8:11], s36 offen lds
    s_mul_i32 s36, s35, 4096
    s_add_u32 m0, s36, 16384
    s_add_u32 s36, s41, 0
    buffer_load_dwordx4 v5, s[12:15], s36 offen lds
    s_mul_i32 s36, s35, 4096
    s_add_u32 m0, s36, 17408
    s_add_u32 s36, s41, 4096
    buffer_load_dwordx4 v5, s[12:15], s36 offen lds
    s_mul_i32 s36, s35, 4096
    s_add_u32 m0, s36, 18432
    s_add_u32 s36, s41, 8192
    buffer_load_dwordx4 v5, s[12:15], s36 offen lds
    s_mul_i32 s36, s35, 4096
    s_add_u32 m0, s36, 19456
    s_add_u32 s36, s41, 12288
    buffer_load_dwordx4 v5, s[12:15], s36 offen lds
    s_add_u32 s40, s40, 128
    s_add_u32 s41, s41, 65536
    s_mul_i32 s36, s35, 4096
    s_add_u32 m0, s36, 32768
    s_add_u32 s36, s40, 0
    buffer_load_dwordx4 v3, s[8:11], s36 offen lds
    s_mul_i32 s36, s35, 4096
    s_add_u32 m0, s36, 33792
    s_add_u32 s36, s40, 65536
    buffer_load_dwordx4 v4, s[8:11], s36 offen lds
    s_mul_i32 s36, s35, 4096
    s_add_u32 m0, s36, 34816
    s_add_u32 s36, s40, 131072
    buffer_load_dwordx4 v3, s[8:11], s36 offen lds
    s_mul_i32 s36, s35, 4096
    s_add_u32 m0, s36, 35840
    s_add_u32 s36, s40, 196608
    buffer_load_dwordx4 v4, s[8:11], s36 offen lds
    s_mul_i32 s36, s35, 4096
    s_add_u32 m0, s36, 49152
    s_add_u32 s36, s41, 0
    buffer_load_dwordx4 v5, s[12:15], s36 offen lds
    s_mul_i32 s36, s35, 4096
    s_add_u32 m0, s36, 50176
    s_add_u32 s36, s41, 4096
    buffer_load_dwordx4 v5, s[12:15], s36 offen lds
    s_mul_i32 s36, s35, 4096
    s_add_u32 m0, s36, 51200
    s_add_u32 s36, s41, 8192
    buffer_load_dwordx4 v5, s[12:15], s36 offen lds
    s_mul_i32 s36, s35, 4096
    s_add_u32 m0, s36, 52224
    s_add_u32 s36, s41, 12288
    buffer_load_dwordx4 v5, s[12:15], s36 offen lds
    s_add_u32 s40, s40, 128
    s_add_u32 s41, s41, 65536
    s_mov_b32 s42, 4
wo_loop2:
    s_waitcnt vmcnt(8)
    s_barrier
    s_mul_i32 s36, s35, 4096
    s_add_u32 m0, s36, 65536
    s_add_u32 s36, s40, 0
    buffer_load_dwordx4 v3, s[8:11], s36 offen lds
    s_mul_i32 s36, s35, 4096
    s_add_u32 m0, s36, 66560
    s_add_u32 s36, s40, 65536
    buffer_load_dwordx4 v4, s[8:11], s36 offen lds
    s_mul_i32 s36, s35, 4096
    s_add_u32 m0, s36, 67584
    s_add_u32 s36, s40, 131072
    buffer_load_dwordx4 v3, s[8:11], s36 offen lds
    s_mul_i32 s36, s35, 4096
    s_add_u32 m0, s36, 68608
    s_add_u32 s36, s40, 196608
    buffer_load_dwordx4 v4, s[8:11], s36 offen lds
    s_mul_i32 s36, s35, 4096
    s_add_u32 m0, s36, 81920
    s_add_u32 s36, s41, 0
    buffer_load_dwordx4 v5, s[12:15], s36 offen lds
    s_mul_i32 s36, s35, 4096
    s_add_u32 m0, s36, 82944
    s_add_u32 s36, s41, 4096
    buffer_load_dwordx4 v5, s[12:15], s36 offen lds
    s_mul_i32 s36, s35, 4096
    s_add_u32 m0, s36, 83968
    s_add_u32 s36, s41, 8192
    buffer_load_dwordx4 v5, s[12:15], s36 offen lds
    s_mul_i32 s36, s35, 4096
    s_add_u32 m0, s36, 84992
    s_add_u32 s36, s41, 12288
    buffer_load_dwordx4 v5, s[12:15], s36 offen lds
    s_add_u32 s40, s40, 128
    s_add_u32 s41, s41, 65536
    ds_read_b128 v[28:31], v10 offset:0
    ds_read_b128 v[32:35], v10 offset:4096
    ds_read_b64_tr_b16 v[36:37], v14 offset:0
    ds_read_b64_tr_b16 v[38:39], v14 offset:1024
    ds_read_b64_tr_b16 v[40:41], v15 offset:0
    ds_read_b64_tr_b16 v[42:43], v15 offset:1024
    ds_read_b128 v[44:47], v11 offset:0
    ds_read_b128 v[48:51], v11 offset:4096
    ds_read_b64_tr_b16 v[52:53], v14 offset:4096
    ds_read_b64_tr_b16 v[54:55], v14 offset:5120
    ds_read_b64_tr_b16 v[56:57], v15 offset:4096
    ds_read_b64_tr_b16 v[58:59], v15 offset:5120
    s_waitcnt lgkmcnt(6)
    v_mfma_f32_32x32x16_bf16 v[60:75], v[36:39], v[28:31], v[60:75]
    v_mfma_f32_32x32x16_bf16 v[76:91], v[40:43], v[28:31], v[76:91]
    v_mfma_f32_32x32x16_bf16 v[92:107], v[36:39], v[32:35], v[92:107]
    v_mfma_f32_32x32x16_bf16 v[108:123], v[40:43], v[32:35], v[108:123]
    ds_read_b128 v[28:31], v12 offset:0
    ds_read_b128 v[32:35], v12 offset:4096
    ds_read_b64_tr_b16 v[36:37], v14 offset:8192
    ds_read_b64_tr_b16 v[38:39], v14 offset:9216
    ds_read_b64_tr_b16 v[40:41], v15 offset:8192
    ds_read_b64_tr_b16 v[42:43], v15 offset:9216
    s_waitcnt lgkmcnt(6)
    v_mfma_f32_32x32x16_bf16 v[60:75], v[52:55], v[44:47], v[60:75]
    v_mfma_f32_32x32x16_bf16 v[76:91], v[56:59], v[44:47], v[76:91]
    v_mfma_f32_32x32x16_bf16 v[92:107], v[52:55], v[48:51], v[92:107]
    v_mfma_f32_32x32x16_bf16 v[108:123], v[56:59], v[48:51], v[108:123]
    ds_read_b128 v[44:47], v13 offset:0
    ds_read_b128 v[48:51], v13 offset:4096
    ds_read_b64_tr_b16 v[52:53], v14 offset:12288
    ds_read_b64_tr_b16 v[54:55], v14 offset:13312
    ds_read_b64_tr_b16 v[56:57], v15 offset:12288
    ds_read_b64_tr_b16 v[58:59], v15 offset:13312
    s_waitcnt lgkmcnt(6)
    v_mfma_f32_32x32x16_bf16 v[60:75], v[36:39], v[28:31], v[60:75]
    v_mfma_f32_32x32x16_bf16 v[76:91], v[40:43], v[28:31], v[76:91]
    v_mfma_f32_32x32x16_bf16 v[92:107], v[36:39], v[32:35], v[92:107]
    v_mfma_f32_32x32x16_bf16 v[108:123], v[40:43], v[32:35], v[108:123]
    s_waitcnt lgkmcnt(0)
    v_mfma_f32_32x32x16_bf16 v[60:75], v[52:55], v[44:47], v[60:75]
    v_mfma_f32_32x32x16_bf16 v[76:91], v[56:59], v[44:47], v[76:91]
    v_mfma_f32_32x32x16_bf16 v[92:107], v[52:55], v[48:51], v[92:107]
    v_mfma_f32_32x32x16_bf16 v[108:123], v[56:59], v[48:51], v[108:123]
    s_waitcnt vmcnt(8)
    s_barrier
    s_mul_i32 s36, s35, 4096
    s_add_u32 m0, s36, 0
    s_add_u32 s36, s40, 0
    buffer_load_dwordx4 v3, s[8:11], s36 offen lds
    s_mul_i32 s36, s35, 4096
    s_add_u32 m0, s36, 1024
    s_add_u32 s36, s40, 65536
    buffer_load_dwordx4 v4, s[8:11], s36 offen lds
    s_mul_i32 s36, s35, 4096
    s_add_u32 m0, s36, 2048
    s_add_u32 s36, s40, 131072
    buffer_load_dwordx4 v3, s[8:11], s36 offen lds
    s_mul_i32 s36, s35, 4096
    s_add_u32 m0, s36, 3072
    s_add_u32 s36, s40, 196608
    buffer_load_dwordx4 v4, s[8:11], s36 offen lds
    s_mul_i32 s36, s35, 4096
    s_add_u32 m0, s36, 16384
    s_add_u32 s36, s41, 0
    buffer_load_dwordx4 v5, s[12:15], s36 offen lds
    s_mul_i32 s36, s35, 4096
    s_add_u32 m0, s36, 17408
    s_add_u32 s36, s41, 4096
    buffer_load_dwordx4 v5, s[12:15], s36 offen lds
    s_mul_i32 s36, s35, 4096
    s_add_u32 m0, s36, 18432
    s_add_u32 s36, s41, 8192
    buffer_load_dwordx4 v5, s[12:15], s36 offen lds
    s_mul_i32 s36, s35, 4096
    s_add_u32 m0, s36, 19456
    s_add_u32 s36, s41, 12288
    buffer_load_dwordx4 v5, s[12:15], s36 offen lds
    s_add_u32 s40, s40, 128
    s_add_u32 s41, s41, 65536
    ds_read_b128 v[28:31], v10 offset:32768
    ds_read_b128 v[32:35], v10 offset:36864
    ds_read_b64_tr_b16 v[36:37], v14 offset:32768
    ds_read_b64_tr_b16 v[38:39], v14 offset:33792
    ds_read_b64_tr_b16 v[40:41], v15 offset:32768
    ds_read_b64_tr_b16 v[42:43], v15 offset:33792
    ds_read_b128 v[44:47], v11 offset:32768
    ds_read_b128 v[48:51], v11 offset:36864
    ds_read_b64_tr_b16 v[52:53], v14 offset:36864
    ds_read_b64_tr_b16 v[54:55], v14 offset:37888
    ds_read_b64_tr_b16 v[56:57], v15 offset:36864
    ds_read_b64_tr_b16 v[58:59], v15 offset:37888
    s_waitcnt lgkmcnt(6)
    v_mfma_f32_32x32x16_bf16 v[60:75], v[36:39], v[28:31], v[60:75]
    v_mfma_f32_32x32x16_bf16 v[76:91], v[40:43], v[28:31], v[76:91]
    v_mfma_f32_32x32x16_bf16 v[92:107], v[36:39], v[32:35], v[92:107]
    v_mfma_f32_32x32x16_bf16 v[108:123], v[40:43], v[32:35], v[108:123]
    ds_read_b128 v[28:31], v12 offset:32768
    ds_read_b128 v[32:35], v12 offset:36864
    ds_read_b64_tr_b16 v[36:37], v14 offset:40960
    ds_read_b64_tr_b16 v[38:39], v14 offset:41984
    ds_read_b64_tr_b16 v[40:41], v15 offset:40960
    ds_read_b64_tr_b16 v[42:43], v15 offset:41984
    s_waitcnt lgkmcnt(6)
    v_mfma_f32_32x32x16_bf16 v[60:75], v[52:55], v[44:47], v[60:75]
    v_mfma_f32_32x32x16_bf16 v[76:91], v[56:59], v[44:47], v[76:91]
    v_mfma_f32_32x32x16_bf16 v[92:107], v[52:55], v[48:51], v[92:107]
    v_mfma_f32_32x32x16_bf16 v[108:123], v[56:59], v[48:51], v[108:123]
    ds_read_b128 v[44:47], v13 offset:32768
    ds_read_b128 v[48:51], v13 offset:36864
    ds_read_b64_tr_b16 v[52:53], v14 offset:45056
    ds_read_b64_tr_b16 v[54:55], v14 offset:46080
    ds_read_b64_tr_b16 v[56:57], v15 offset:45056
    ds_read_b64_tr_b16 v[58:59], v15 offset:46080
    s_waitcnt lgkmcnt(6)
    v_mfma_f32_32x32x16_bf16 v[60:75], v[36:39], v[28:31], v[60:75]
    v_mfma_f32_32x32x16_bf16 v[76:91], v[40:43], v[28:31], v[76:91]
    v_mfma_f32_32x32x16_bf16 v[92:107], v[36:39], v[32:35], v[92:107]
    v_mfma_f32_32x32x16_bf16 v[108:123], v[40:43], v[32:35], v[108:123]
    s_waitcnt lgkmcnt(0)
    v_mfma_f32_32x32x16_bf16 v[60:75], v[52:55], v[44:47], v[60:75]
    v_mfma_f32_32x32x16_bf16 v[76:91], v[56:59], v[44:47], v[76:91]
    v_mfma_f32_32x32x16_bf16 v[92:107], v[52:55], v[48:51], v[92:107]
    v_mfma_f32_32x32x16_bf16 v[108:123], v[56:59], v[48:51], v[108:123]
    s_waitcnt vmcnt(8)
    s_barrier
    s_mul_i32 s36, s35, 4096
    s_add_u32 m0, s36, 32768
    s_add_u32 s36, s40, 0
    buffer_load_dwordx4 v3, s[8:11], s36 offen lds
    s_mul_i32 s36, s35, 4096
    s_add_u32 m0, s36, 33792
    s_add_u32 s36, s40, 65536
    buffer_load_dwordx4 v4, s[8:11], s36 offen lds
    s_mul_i32 s36, s35, 4096
    s_add_u32 m0, s36, 34816
    s_add_u32 s36, s40, 131072
    buffer_load_dwordx4 v3, s[8:11], s36 offen lds
    s_mul_i32 s36, s35, 4096
    s_add_u32 m0, s36, 35840
    s_add_u32 s36, s40, 196608
    buffer_load_dwordx4 v4, s[8:11], s36 offen lds
    s_mul_i32 s36, s35, 4096
    s_add_u32 m0, s36, 49152
    s_add_u32 s36, s41, 0
    buffer_load_dwordx4 v5, s[12:15], s36 offen lds
    s_mul_i32 s36, s35, 4096
    s_add_u32 m0, s36, 50176
    s_add_u32 s36, s41, 4096
    buffer_load_dwordx4 v5, s[12:15], s36 offen lds
    s_mul_i32 s36, s35, 4096
    s_add_u32 m0, s36, 51200
    s_add_u32 s36, s41, 8192
    buffer_load_dwordx4 v5, s[12:15], s36 offen lds
    s_mul_i32 s36, s35, 4096
    s_add_u32 m0, s36, 52224
    s_add_u32 s36, s41, 12288
    buffer_load_dwordx4 v5, s[12:15], s36 offen lds
    s_add_u32 s40, s40, 128
    s_add_u32 s41, s41, 65536
    ds_read_b128 v[28:31], v20 offset:0
    ds_read_b128 v[32:35], v20 offset:4096
    ds_read_b64_tr_b16 v[36:37], v24 offset:0
    ds_read_b64_tr_b16 v[38:39], v24 offset:1024
    ds_read_b64_tr_b16 v[40:41], v25 offset:0
    ds_read_b64_tr_b16 v[42:43], v25 offset:1024
    ds_read_b128 v[44:47], v21 offset:0
    ds_read_b128 v[48:51], v21 offset:4096
    ds_read_b64_tr_b16 v[52:53], v24 offset:4096
    ds_read_b64_tr_b16 v[54:55], v24 offset:5120
    ds_read_b64_tr_b16 v[56:57], v25 offset:4096
    ds_read_b64_tr_b16 v[58:59], v25 offset:5120
    s_waitcnt lgkmcnt(6)
    v_mfma_f32_32x32x16_bf16 v[60:75], v[36:39], v[28:31], v[60:75]
    v_mfma_f32_32x32x16_bf16 v[76:91], v[40:43], v[28:31], v[76:91]
    v_mfma_f32_32x32x16_bf16 v[92:107], v[36:39], v[32:35], v[92:107]
    v_mfma_f32_32x32x16_bf16 v[108:123], v[40:43], v[32:35], v[108:123]
    ds_read_b128 v[28:31], v22 offset:0
    ds_read_b128 v[32:35], v22 offset:4096
    ds_read_b64_tr_b16 v[36:37], v24 offset:8192
    ds_read_b64_tr_b16 v[38:39], v24 offset:9216
    ds_read_b64_tr_b16 v[40:41], v25 offset:8192
    ds_read_b64_tr_b16 v[42:43], v25 offset:9216
    s_waitcnt lgkmcnt(6)
    v_mfma_f32_32x32x16_bf16 v[60:75], v[52:55], v[44:47], v[60:75]
    v_mfma_f32_32x32x16_bf16 v[76:91], v[56:59], v[44:47], v[76:91]
    v_mfma_f32_32x32x16_bf16 v[92:107], v[52:55], v[48:51], v[92:107]
    v_mfma_f32_32x32x16_bf16 v[108:123], v[56:59], v[48:51], v[108:123]
    ds_read_b128 v[44:47], v23 offset:0
    ds_read_b128 v[48:51], v23 offset:4096
    ds_read_b64_tr_b16 v[52:53], v24 offset:12288
    ds_read_b64_tr_b16 v[54:55], v24 offset:13312
    ds_read_b64_tr_b16 v[56:57], v25 offset:12288
    ds_read_b64_tr_b16 v[58:59], v25 offset:13312
    s_waitcnt lgkmcnt(6)
    v_mfma_f32_32x32x16_bf16 v[60:75], v[36:39], v[28:31], v[60:75]
    v_mfma_f32_32x32x16_bf16 v[76:91], v[40:43], v[28:31], v[76:91]
    v_mfma_f32_32x32x16_bf16 v[92:107], v[36:39], v[32:35], v[92:107]
    v_mfma_f32_32x32x16_bf16 v[108:123], v[40:43], v[32:35], v[108:123]
    s_waitcnt lgkmcnt(0)
    v_mfma_f32_32x32x16_bf16 v[60:75], v[52:55], v[44:47], v[60:75]
    v_mfma_f32_32x32x16_bf16 v[76:91], v[56:59], v[44:47], v[76:91]
    v_mfma_f32_32x32x16_bf16 v[92:107], v[52:55], v[48:51], v[92:107]
    v_mfma_f32_32x32x16_bf16 v[108:123], v[56:59], v[48:51], v[108:123]
    s_sub_u32 s42, s42, 1
    s_cmp_lg_u32 s42, 0
    s_cbranch_scc1 wo_loop2
    s_waitcnt vmcnt(8)
    s_barrier
    s_mul_i32 s36, s35, 4096
    s_add_u32 m0, s36, 65536
    s_add_u32 s36, s40, 0
    buffer_load_dwordx4 v3, s[8:11], s36 offen lds
    s_mul_i32 s36, s35, 4096
    s_add_u32 m0, s36, 66560
    s_add_u32 s36, s40, 65536
    buffer_load_dwordx4 v4, s[8:11], s36 offen lds
    s_mul_i32 s36, s35, 4096
    s_add_u32 m0, s36, 67584
    s_add_u32 s36, s40, 131072
    buffer_load_dwordx4 v3, s[8:11], s36 offen lds
    s_mul_i32 s36, s35, 4096
    s_add_u32 m0, s36, 68608
    s_add_u32 s36, s40, 196608
    buffer_load_dwordx4 v4, s[8:11], s36 offen lds
    s_mul_i32 s36, s35, 4096
    s_add_u32 m0, s36, 81920
    s_add_u32 s36, s41, 0
    buffer_load_dwordx4 v5, s[12:15], s36 offen lds
    s_mul_i32 s36, s35, 4096
    s_add_u32 m0, s36, 82944
    s_add_u32 s36, s41, 4096
    buffer_load_dwordx4 v5, s[12:15], s36 offen lds
    s_mul_i32 s36, s35, 4096
    s_add_u32 m0, s36, 83968
    s_add_u32 s36, s41, 8192
    buffer_load_dwordx4 v5, s[12:15], s36 offen lds
    s_mul_i32 s36, s35, 4096
    s_add_u32 m0, s36, 84992
    s_add_u32 s36, s41, 12288
    buffer_load_dwordx4 v5, s[12:15], s36 offen lds
    s_add_u32 s40, s40, 128
    s_add_u32 s41, s41, 65536
    ds_read_b128 v[28:31], v10 offset:0
    ds_read_b128 v[32:35], v10 offset:4096
    ds_read_b64_tr_b16 v[36:37], v14 offset:0
    ds_read_b64_tr_b16 v[38:39], v14 offset:1024
    ds_read_b64_tr_b16 v[40:41], v15 offset:0
    ds_read_b64_tr_b16 v[42:43], v15 offset:1024
    ds_read_b128 v[44:47], v11 offset:0
    ds_read_b128 v[48:51], v11 offset:4096
    ds_read_b64_tr_b16 v[52:53], v14 offset:4096
    ds_read_b64_tr_b16 v[54:55], v14 offset:5120
    ds_read_b64_tr_b16 v[56:57], v15 offset:4096
    ds_read_b64_tr_b16 v[58:59], v15 offset:5120
    s_waitcnt lgkmcnt(6)
    v_mfma_f32_32x32x16_bf16 v[60:75], v[36:39], v[28:31], v[60:75]
    v_mfma_f32_32x32x16_bf16 v[76:91], v[40:43], v[28:31], v[76:91]
    v_mfma_f32_32x32x16_bf16 v[92:107], v[36:39], v[32:35], v[92:107]
    v_mfma_f32_32x32x16_bf16 v[108:123], v[40:43], v[32:35], v[108:123]
    ds_read_b128 v[28:31], v12 offset:0
    ds_read_b128 v[32:35], v12 offset:4096
    ds_read_b64_tr_b16 v[36:37], v14 offset:8192
    ds_read_b64_tr_b16 v[38:39], v14 offset:9216
    ds_read_b64_tr_b16 v[40:41], v15 offset:8192
    ds_read_b64_tr_b16 v[42:43], v15 offset:9216
    s_waitcnt lgkmcnt(6)
    v_mfma_f32_32x32x16_bf16 v[60:75], v[52:55], v[44:47], v[60:75]
    v_mfma_f32_32x32x16_bf16 v[76:91], v[56:59], v[44:47], v[76:91]
    v_mfma_f32_32x32x16_bf16 v[92:107], v[52:55], v[48:51], v[92:107]
    v_mfma_f32_32x32x16_bf16 v[108:123], v[56:59], v[48:51], v[108:123]
    ds_read_b128 v[44:47], v13 offset:0
    ds_read_b128 v[48:51], v13 offset:4096
    ds_read_b64_tr_b16 v[52:53], v14 offset:12288
    ds_read_b64_tr_b16 v[54:55], v14 offset:13312
    ds_read_b64_tr_b16 v[56:57], v15 offset:12288
    ds_read_b64_tr_b16 v[58:59], v15 offset:13312
    s_waitcnt lgkmcnt(6)
    v_mfma_f32_32x32x16_bf16 v[60:75], v[36:39], v[28:31], v[60:75]
    v_mfma_f32_32x32x16_bf16 v[76:91], v[40:43], v[28:31], v[76:91]
    v_mfma_f32_32x32x16_bf16 v[92:107], v[36:39], v[32:35], v[92:107]
    v_mfma_f32_32x32x16_bf16 v[108:123], v[40:43], v[32:35], v[108:123]
    s_waitcnt lgkmcnt(0)
    v_mfma_f32_32x32x16_bf16 v[60:75], v[52:55], v[44:47], v[60:75]
    v_mfma_f32_32x32x16_bf16 v[76:91], v[56:59], v[44:47], v[76:91]
    v_mfma_f32_32x32x16_bf16 v[92:107], v[52:55], v[48:51], v[92:107]
    v_mfma_f32_32x32x16_bf16 v[108:123], v[56:59], v[48:51], v[108:123]
    s_waitcnt vmcnt(8)
    s_barrier
    s_mul_i32 s36, s35, 4096
    s_add_u32 m0, s36, 0
    s_add_u32 s36, s40, 0
    buffer_load_dwordx4 v3, s[8:11], s36 offen lds
    s_mul_i32 s36, s35, 4096
    s_add_u32 m0, s36, 1024
    s_add_u32 s36, s40, 65536
    buffer_load_dwordx4 v4, s[8:11], s36 offen lds
    s_mul_i32 s36, s35, 4096
    s_add_u32 m0, s36, 2048
    s_add_u32 s36, s40, 131072
    buffer_load_dwordx4 v3, s[8:11], s36 offen lds
    s_mul_i32 s36, s35, 4096
    s_add_u32 m0, s36, 3072
    s_add_u32 s36, s40, 196608
    buffer_load_dwordx4 v4, s[8:11], s36 offen lds
    s_mul_i32 s36, s35, 4096
    s_add_u32 m0, s36, 16384
    s_add_u32 s36, s41, 0
    buffer_load_dwordx4 v5, s[12:15], s36 offen lds
    s_mul_i32 s36, s35, 4096
    s_add_u32 m0, s36, 17408
    s_add_u32 s36, s41, 4096
    buffer_load_dwordx4 v5, s[12:15], s36 offen lds
    s_mul_i32 s36, s35, 4096
    s_add_u32 m0, s36, 18432
    s_add_u32 s36, s41, 8192
    buffer_load_dwordx4 v5, s[12:15], s36 offen lds
    s_mul_i32 s36, s35, 4096
    s_add_u32 m0, s36, 19456
    s_add_u32 s36, s41, 12288
    buffer_load_dwordx4 v5, s[12:15], s36 offen lds
    s_add_u32 s40, s40, 128
    s_add_u32 s41, s41, 65536
    ds_read_b128 v[28:31], v10 offset:32768
    ds_read_b128 v[32:35], v10 offset:36864
    ds_read_b64_tr_b16 v[36:37], v14 offset:32768
    ds_read_b64_tr_b16 v[38:39], v14 offset:33792
    ds_read_b64_tr_b16 v[40:41], v15 offset:32768
    ds_read_b64_tr_b16 v[42:43], v15 offset:33792
    ds_read_b128 v[44:47], v11 offset:32768
    ds_read_b128 v[48:51], v11 offset:36864
    ds_read_b64_tr_b16 v[52:53], v14 offset:36864
    ds_read_b64_tr_b16 v[54:55], v14 offset:37888
    ds_read_b64_tr_b16 v[56:57], v15 offset:36864
    ds_read_b64_tr_b16 v[58:59], v15 offset:37888
    s_waitcnt lgkmcnt(6)
    v_mfma_f32_32x32x16_bf16 v[60:75], v[36:39], v[28:31], v[60:75]
    v_mfma_f32_32x32x16_bf16 v[76:91], v[40:43], v[28:31], v[76:91]
    v_mfma_f32_32x32x16_bf16 v[92:107], v[36:39], v[32:35], v[92:107]
    v_mfma_f32_32x32x16_bf16 v[108:123], v[40:43], v[32:35], v[108:123]
    ds_read_b128 v[28:31], v12 offset:32768
    ds_read_b128 v[32:35], v12 offset:36864
    ds_read_b64_tr_b16 v[36:37], v14 offset:40960
    ds_read_b64_tr_b16 v[38:39], v14 offset:41984
    ds_read_b64_tr_b16 v[40:41], v15 offset:40960
    ds_read_b64_tr_b16 v[42:43], v15 offset:41984
    s_waitcnt lgkmcnt(6)
    v_mfma_f32_32x32x16_bf16 v[60:75], v[52:55], v[44:47], v[60:75]
    v_mfma_f32_32x32x16_bf16 v[76:91], v[56:59], v[44:47], v[76:91]
    v_mfma_f32_32x32x16_bf16 v[92:107], v[52:55], v[48:51], v[92:107]
    v_mfma_f32_32x32x16_bf16 v[108:123], v[56:59], v[48:51], v[108:123]
    ds_read_b128 v[44:47], v13 offset:32768
    ds_read_b128 v[48:51], v13 offset:36864
    ds_read_b64_tr_b16 v[52:53], v14 offset:45056
    ds_read_b64_tr_b16 v[54:55], v14 offset:46080
    ds_read_b64_tr_b16 v[56:57], v15 offset:45056
    ds_read_b64_tr_b16 v[58:59], v15 offset:46080
    s_waitcnt lgkmcnt(6)
    v_mfma_f32_32x32x16_bf16 v[60:75], v[36:39], v[28:31], v[60:75]
    v_mfma_f32_32x32x16_bf16 v[76:91], v[40:43], v[28:31], v[76:91]
    v_mfma_f32_32x32x16_bf16 v[92:107], v[36:39], v[32:35], v[92:107]
    v_mfma_f32_32x32x16_bf16 v[108:123], v[40:43], v[32:35], v[108:123]
    s_waitcnt lgkmcnt(0)
    v_mfma_f32_32x32x16_bf16 v[60:75], v[52:55], v[44:47], v[60:75]
    v_mfma_f32_32x32x16_bf16 v[76:91], v[56:59], v[44:47], v[76:91]
    v_mfma_f32_32x32x16_bf16 v[92:107], v[52:55], v[48:51], v[92:107]
    v_mfma_f32_32x32x16_bf16 v[108:123], v[56:59], v[48:51], v[108:123]
    s_waitcnt vmcnt(8)
    s_barrier
    ds_read_b128 v[28:31], v20 offset:0
    ds_read_b128 v[32:35], v20 offset:4096
    ds_read_b64_tr_b16 v[36:37], v24 offset:0
    ds_read_b64_tr_b16 v[38:39], v24 offset:1024
    ds_read_b64_tr_b16 v[40:41], v25 offset:0
    ds_read_b64_tr_b16 v[42:43], v25 offset:1024
    ds_read_b128 v[44:47], v21 offset:0
    ds_read_b128 v[48:51], v21 offset:4096
    ds_read_b64_tr_b16 v[52:53], v24 offset:4096
    ds_read_b64_tr_b16 v[54:55], v24 offset:5120
    ds_read_b64_tr_b16 v[56:57], v25 offset:4096
    ds_read_b64_tr_b16 v[58:59], v25 offset:5120
    s_waitcnt lgkmcnt(6)
    v_mfma_f32_32x32x16_bf16 v[60:75], v[36:39], v[28:31], v[60:75]
    v_mfma_f32_32x32x16_bf16 v[76:91], v[40:43], v[28:31], v[76:91]
    v_mfma_f32_32x32x16_bf16 v[92:107], v[36:39], v[32:35], v[92:107]
    v_mfma_f32_32x32x16_bf16 v[108:123], v[40:43], v[32:35], v[108:123]
    ds_read_b128 v[28:31], v22 offset:0
    ds_read_b128 v[32:35], v22 offset:4096
    ds_read_b64_tr_b16 v[36:37], v24 offset:8192
    ds_read_b64_tr_b16 v[38:39], v24 offset:9216
    ds_read_b64_tr_b16 v[40:41], v25 offset:8192
    ds_read_b64_tr_b16 v[42:43], v25 offset:9216
    s_waitcnt lgkmcnt(6)
    v_mfma_f32_32x32x16_bf16 v[60:75], v[52:55], v[44:47], v[60:75]
    v_mfma_f32_32x32x16_bf16 v[76:91], v[56:59], v[44:47], v[76:91]
    v_mfma_f32_32x32x16_bf16 v[92:107], v[52:55], v[48:51], v[92:107]
    v_mfma_f32_32x32x16_bf16 v[108:123], v[56:59], v[48:51], v[108:123]
    ds_read_b128 v[44:47], v23 offset:0
    ds_read_b128 v[48:51], v23 offset:4096
    ds_read_b64_tr_b16 v[52:53], v24 offset:12288
    ds_read_b64_tr_b16 v[54:55], v24 offset:13312
    ds_read_b64_tr_b16 v[56:57], v25 offset:12288
    ds_read_b64_tr_b16 v[58:59], v25 offset:13312
    s_waitcnt lgkmcnt(6)
    v_mfma_f32_32x32x16_bf16 v[60:75], v[36:39], v[28:31], v[60:75]
    v_mfma_f32_32x32x16_bf16 v[76:91], v[40:43], v[28:31], v[76:91]
    v_mfma_f32_32x32x16_bf16 v[92:107], v[36:39], v[32:35], v[92:107]
    v_mfma_f32_32x32x16_bf16 v[108:123], v[40:43], v[32:35], v[108:123]
    s_waitcnt lgkmcnt(0)
    v_mfma_f32_32x32x16_bf16 v[60:75], v[52:55], v[44:47], v[60:75]
    v_mfma_f32_32x32x16_bf16 v[76:91], v[56:59], v[44:47], v[76:91]
    v_mfma_f32_32x32x16_bf16 v[92:107], v[52:55], v[48:51], v[92:107]
    v_mfma_f32_32x32x16_bf16 v[108:123], v[56:59], v[48:51], v[108:123]
    s_waitcnt vmcnt(0)
    s_barrier
    ds_read_b128 v[28:31], v10 offset:0
    ds_read_b128 v[32:35], v10 offset:4096
    ds_read_b64_tr_b16 v[36:37], v14 offset:0
    ds_read_b64_tr_b16 v[38:39], v14 offset:1024
    ds_read_b64_tr_b16 v[40:41], v15 offset:0
    ds_read_b64_tr_b16 v[42:43], v15 offset:1024
    ds_read_b128 v[44:47], v11 offset:0
    ds_read_b128 v[48:51], v11 offset:4096
    ds_read_b64_tr_b16 v[52:53], v14 offset:4096
    ds_read_b64_tr_b16 v[54:55], v14 offset:5120
    ds_read_b64_tr_b16 v[56:57], v15 offset:4096
    ds_read_b64_tr_b16 v[58:59], v15 offset:5120
    s_waitcnt lgkmcnt(6)
    v_mfma_f32_32x32x16_bf16 v[60:75], v[36:39], v[28:31], v[60:75]
    v_mfma_f32_32x32x16_bf16 v[76:91], v[40:43], v[28:31], v[76:91]
    v_mfma_f32_32x32x16_bf16 v[92:107], v[36:39], v[32:35], v[92:107]
    v_mfma_f32_32x32x16_bf16 v[108:123], v[40:43], v[32:35], v[108:123]
    ds_read_b128 v[28:31], v12 offset:0
    ds_read_b128 v[32:35], v12 offset:4096
    ds_read_b64_tr_b16 v[36:37], v14 offset:8192
    ds_read_b64_tr_b16 v[38:39], v14 offset:9216
    ds_read_b64_tr_b16 v[40:41], v15 offset:8192
    ds_read_b64_tr_b16 v[42:43], v15 offset:9216
    s_waitcnt lgkmcnt(6)
    v_mfma_f32_32x32x16_bf16 v[60:75], v[52:55], v[44:47], v[60:75]
    v_mfma_f32_32x32x16_bf16 v[76:91], v[56:59], v[44:47], v[76:91]
    v_mfma_f32_32x32x16_bf16 v[92:107], v[52:55], v[48:51], v[92:107]
    v_mfma_f32_32x32x16_bf16 v[108:123], v[56:59], v[48:51], v[108:123]
    ds_read_b128 v[44:47], v13 offset:0
    ds_read_b128 v[48:51], v13 offset:4096
    ds_read_b64_tr_b16 v[52:53], v14 offset:12288
    ds_read_b64_tr_b16 v[54:55], v14 offset:13312
    ds_read_b64_tr_b16 v[56:57], v15 offset:12288
    ds_read_b64_tr_b16 v[58:59], v15 offset:13312
    s_waitcnt lgkmcnt(6)
    v_mfma_f32_32x32x16_bf16 v[60:75], v[36:39], v[28:31], v[60:75]
    v_mfma_f32_32x32x16_bf16 v[76:91], v[40:43], v[28:31], v[76:91]
    v_mfma_f32_32x32x16_bf16 v[92:107], v[36:39], v[32:35], v[92:107]
    v_mfma_f32_32x32x16_bf16 v[108:123], v[40:43], v[32:35], v[108:123]
    s_waitcnt lgkmcnt(0)
    v_mfma_f32_32x32x16_bf16 v[60:75], v[52:55], v[44:47], v[60:75]
    v_mfma_f32_32x32x16_bf16 v[76:91], v[56:59], v[44:47], v[76:91]
    v_mfma_f32_32x32x16_bf16 v[92:107], v[52:55], v[48:51], v[92:107]
    v_mfma_f32_32x32x16_bf16 v[108:123], v[56:59], v[48:51], v[108:123]
    s_nop 15
    s_nop 7
    s_barrier
    v_and_b32 v6, 31, v2
    v_mul_u32_u24 v6, 272, v6
    v_lshrrev_b32 v7, 5, v2
    v_lshlrev_b32 v7, 4, v7
    v_add_u32 v6, v6, v7
    s_mul_i32 s36, s35, 17408
    v_add_u32 v6, s36, v6
    ds_write_b128 v6, v[60:63] offset:0
    ds_write_b128 v6, v[64:67] offset:32
    ds_write_b128 v6, v[68:71] offset:64
    ds_write_b128 v6, v[72:75] offset:96
    ds_write_b128 v6, v[76:79] offset:128
    ds_write_b128 v6, v[80:83] offset:160
    ds_write_b128 v6, v[84:87] offset:192
    ds_write_b128 v6, v[88:91] offset:224
    ds_write_b128 v6, v[92:95] offset:8704
    ds_write_b128 v6, v[96:99] offset:8736
    ds_write_b128 v6, v[100:103] offset:8768
    ds_write_b128 v6, v[104:107] offset:8800
    ds_write_b128 v6, v[108:111] offset:8832
    ds_write_b128 v6, v[112:115] offset:8864
    ds_write_b128 v6, v[116:119] offset:8896
    ds_write_b128 v6, v[120:123] offset:8928
    v_lshrrev_b32 v8, 4, v2
    v_and_b32 v9, 15, v2
    v_mul_u32_u24 v6, 272, v8
    v_lshlrev_b32 v7, 4, v9
    v_add_u32 v6, v6, v7
    v_add_u32 v6, s36, v6
    s_mul_i32 s36, s37, 64
    s_add_u32 s36, s36, s33
    v_add_u32 v8, s36, v8
    v_lshlrev_b32 v9, 2, v9
    s_mul_i32 s36, s38, 64
    s_add_u32 s36, s36, s34
    v_add_u32 v9, s36, v9
    v_mul_u32_u24 v10, 2048, v8
    v_lshlrev_b32 v11, 2, v9
    v_add_u32 v10, v10, v11
    s_mul_i32 s36, s39, 4194304
    v_add_u32 v10, s36, v10
    ds_read_b128 v[60:63], v6 offset:0
    ds_read_b128 v[72:75], v6 offset:1088
    ds_read_b128 v[84:87], v6 offset:2176
    ds_read_b128 v[96:99], v6 offset:3264
    s_waitcnt vmcnt(0) lgkmcnt(3)
    s_mov_b32 s36, 0
    buffer_store_dwordx4 v[60:63], v10, s[16:19], s36 offen
    s_waitcnt vmcnt(1) lgkmcnt(2)
    s_mov_b32 s36, 8192
    buffer_store_dwordx4 v[72:75], v10, s[16:19], s36 offen
    s_waitcnt vmcnt(2) lgkmcnt(1)
    s_mov_b32 s36, 16384
    buffer_store_dwordx4 v[84:87], v10, s[16:19], s36 offen
    s_waitcnt vmcnt(3) lgkmcnt(0)
    s_mov_b32 s36, 24576
    buffer_store_dwordx4 v[96:99], v10, s[16:19], s36 offen
    ds_read_b128 v[60:63], v6 offset:4352
    ds_read_b128 v[72:75], v6 offset:5440
    ds_read_b128 v[84:87], v6 offset:6528
    ds_read_b128 v[96:99], v6 offset:7616
    s_waitcnt vmcnt(0) lgkmcnt(3)
    s_mov_b32 s36, 32768
    buffer_store_dwordx4 v[60:63], v10, s[16:19], s36 offen
    s_waitcnt vmcnt(1) lgkmcnt(2)
    s_mov_b32 s36, 40960
    buffer_store_dwordx4 v[72:75], v10, s[16:19], s36 offen
    s_waitcnt vmcnt(2) lgkmcnt(1)
    s_mov_b32 s36, 49152
    buffer_store_dwordx4 v[84:87], v10, s[16:19], s36 offen
    s_waitcnt vmcnt(3) lgkmcnt(0)
    s_mov_b32 s36, 57344
    buffer_store_dwordx4 v[96:99], v10, s[16:19], s36 offen
    ds_read_b128 v[60:63], v6 offset:8704
    ds_read_b128 v[72:75], v6 offset:9792
    ds_read_b128 v[84:87], v6 offset:10880
    ds_read_b128 v[96:99], v6 offset:11968
    s_waitcnt vmcnt(0) lgkmcnt(3)
    s_mov_b32 s36, 65536
    buffer_store_dwordx4 v[60:63], v10, s[16:19], s36 offen
    s_waitcnt vmcnt(1) lgkmcnt(2)
    s_mov_b32 s36, 73728
    buffer_store_dwordx4 v[72:75], v10, s[16:19], s36 offen
    s_waitcnt vmcnt(2) lgkmcnt(1)
    s_mov_b32 s36, 81920
    buffer_store_dwordx4 v[84:87], v10, s[16:19], s36 offen
    s_waitcnt vmcnt(3) lgkmcnt(0)
    s_mov_b32 s36, 90112
    buffer_store_dwordx4 v[96:99], v10, s[16:19], s36 offen
    ds_read_b128 v[60:63], v6 offset:13056
    ds_read_b128 v[72:75], v6 offset:14144
    ds_read_b128 v[84:87], v6 offset:15232
    ds_read_b128 v[96:99], v6 offset:16320
    s_waitcnt vmcnt(0) lgkmcnt(3)
    s_mov_b32 s36, 98304
    buffer_store_dwordx4 v[60:63], v10, s[16:19], s36 offen
    s_waitcnt vmcnt(1) lgkmcnt(2)
    s_mov_b32 s36, 106496
    buffer_store_dwordx4 v[72:75], v10, s[16:19], s36 offen
    s_waitcnt vmcnt(2) lgkmcnt(1)
    s_mov_b32 s36, 114688
    buffer_store_dwordx4 v[84:87], v10, s[16:19], s36 offen
    s_waitcnt vmcnt(3) lgkmcnt(0)
    s_mov_b32 s36, 122880
    buffer_store_dwordx4 v[96:99], v10, s[16:19], s36 offen
wo_done1:
    s_endpgm
.globl ln2_kernel
.p2align 8
.type ln2_kernel,@function
ln2_kernel:
    s_cmp_ge_u32 s2, 512
    s_cbranch_scc1 ln2_done1
    s_load_dwordx2 s[8:9], s[0:1], 112
    s_load_dwordx2 s[4:5], s[0:1], 0
    s_waitcnt lgkmcnt(0)
    s_mov_b32 s12, s4
    s_mov_b32 s13, s5
    s_and_b32 s13, s13, 0xffff
    s_mov_b32 s14, 2097152
    s_mov_b32 s15, 0x20000
    s_add_u32 s16, s8, 52428800
    s_addc_u32 s17, s9, 0
    s_and_b32 s17, s17, 0xffff
    s_mov_b32 s18, 2097152
    s_mov_b32 s19, 0x20000
    s_mov_b32 s20, s8
    s_mov_b32 s21, s9
    s_and_b32 s21, s21, 0xffff
    s_mov_b32 s22, 12288
    s_mov_b32 s23, 0x20000
    s_add_u32 s28, s8, 75497472
    s_addc_u32 s29, s9, 0
    s_and_b32 s29, s29, 0xffff
    s_mov_b32 s30, 33554432
    s_mov_b32 s31, 0x20000
    s_add_u32 s32, s8, 50331648
    s_addc_u32 s33, s9, 0
    s_and_b32 s33, s33, 0xffff
    s_mov_b32 s34, 2097152
    s_mov_b32 s35, 0x20000
    v_lshrrev_b32 v1, 6, v0
    v_and_b32 v2, 63, v0
    s_lshl_b32 s24, s2, 2
    v_add_u32 v1, s24, v1
    v_mul_u32_u24 v3, 1024, v1
    v_lshlrev_b32 v4, 2, v2
    v_add_u32 v3, v3, v4
    v_mul_u32_u24 v5, 1024, v1
    v_add_u32 v5, v5, v4
    buffer_load_dword v10, v3, s[12:15], 0 offen offset:0
    buffer_load_dword v11, v3, s[12:15], 0 offen offset:256
    buffer_load_dword v12, v3, s[12:15], 0 offen offset:512
    buffer_load_dword v13, v3, s[12:15], 0 offen offset:768
    v_lshlrev_b32 v6, 3, v2
    v_lshlrev_b32 v8, 11, v1
    v_add_u32 v8, v8, v6
    s_mov_b32 s25, 0
    buffer_load_dwordx2 v[96:97], v8, s[28:31], s25 offen offset:0
    buffer_load_dwordx2 v[98:99], v8, s[28:31], s25 offen offset:512
    buffer_load_dwordx2 v[100:101], v8, s[28:31], s25 offen offset:1024
    buffer_load_dwordx2 v[102:103], v8, s[28:31], s25 offen offset:1536
    s_mov_b32 s25, 4194304
    buffer_load_dwordx2 v[104:105], v8, s[28:31], s25 offen offset:0
    buffer_load_dwordx2 v[106:107], v8, s[28:31], s25 offen offset:512
    buffer_load_dwordx2 v[108:109], v8, s[28:31], s25 offen offset:1024
    buffer_load_dwordx2 v[110:111], v8, s[28:31], s25 offen offset:1536
    s_mov_b32 s25, 8388608
    buffer_load_dwordx2 v[112:113], v8, s[28:31], s25 offen offset:0
    buffer_load_dwordx2 v[114:115], v8, s[28:31], s25 offen offset:512
    buffer_load_dwordx2 v[116:117], v8, s[28:31], s25 offen offset:1024
    buffer_load_dwordx2 v[118:119], v8, s[28:31], s25 offen offset:1536
    s_mov_b32 s25, 12582912
    buffer_load_dwordx2 v[120:121], v8, s[28:31], s25 offen offset:0
    buffer_load_dwordx2 v[122:123], v8, s[28:31], s25 offen offset:512
    buffer_load_dwordx2 v[124:125], v8, s[28:31], s25 offen offset:1024
    buffer_load_dwordx2 v[126:127], v8, s[28:31], s25 offen offset:1536
    s_mov_b32 s25, 4096
    buffer_load_dwordx2 v[84:85], v6, s[20:23], s25 offen offset:0
    buffer_load_dwordx2 v[86:87], v6, s[20:23], s25 offen offset:512
    buffer_load_dwordx2 v[88:89], v6, s[20:23], s25 offen offset:1024
    buffer_load_dwordx2 v[90:91], v6, s[20:23], s25 offen offset:1536
    s_waitcnt vmcnt(0)
    v_add_f32 v96, v96, v104
    v_add_f32 v97, v97, v105
    v_add_f32 v96, v96, v112
    v_add_f32 v97, v97, v113
    v_add_f32 v96, v96, v120
    v_add_f32 v97, v97, v121
    v_cvt_pk_bf16_f32 v96, v96, v97
    v_and_b32 v97, 0xffff0000, v96
    v_lshlrev_b32 v96, 16, v96
    v_mul_f32 v96, v96, v84
    v_mul_f32 v97, v97, v85
    v_cvt_pk_bf16_f32 v96, v96, v97
    v_and_b32 v97, 0xffff0000, v96
    v_lshlrev_b32 v96, 16, v96
    v_lshlrev_b32 v104, 16, v10
    v_and_b32 v105, 0xffff0000, v10
    v_add_f32 v96, v96, v104
    v_add_f32 v97, v97, v105
    v_cvt_pk_bf16_f32 v10, v96, v97
    buffer_store_dword v10, v3, s[32:35], 0 offen offset:0
    v_add_f32 v98, v98, v106
    v_add_f32 v99, v99, v107
    v_add_f32 v98, v98, v114
    v_add_f32 v99, v99, v115
    v_add_f32 v98, v98, v122
    v_add_f32 v99, v99, v123
    v_cvt_pk_bf16_f32 v98, v98, v99
    v_and_b32 v99, 0xffff0000, v98
    v_lshlrev_b32 v98, 16, v98
    v_mul_f32 v98, v98, v86
    v_mul_f32 v99, v99, v87
    v_cvt_pk_bf16_f32 v98, v98, v99
    v_and_b32 v99, 0xffff0000, v98
    v_lshlrev_b32 v98, 16, v98
    v_lshlrev_b32 v106, 16, v11
    v_and_b32 v107, 0xffff0000, v11
    v_add_f32 v98, v98, v106
    v_add_f32 v99, v99, v107
    v_cvt_pk_bf16_f32 v11, v98, v99
    buffer_store_dword v11, v3, s[32:35], 0 offen offset:256
    v_add_f32 v100, v100, v108
    v_add_f32 v101, v101, v109
    v_add_f32 v100, v100, v116
    v_add_f32 v101, v101, v117
    v_add_f32 v100, v100, v124
    v_add_f32 v101, v101, v125
    v_cvt_pk_bf16_f32 v100, v100, v101
    v_and_b32 v101, 0xffff0000, v100
    v_lshlrev_b32 v100, 16, v100
    v_mul_f32 v100, v100, v88
    v_mul_f32 v101, v101, v89
    v_cvt_pk_bf16_f32 v100, v100, v101
    v_and_b32 v101, 0xffff0000, v100
    v_lshlrev_b32 v100, 16, v100
    v_lshlrev_b32 v108, 16, v12
    v_and_b32 v109, 0xffff0000, v12
    v_add_f32 v100, v100, v108
    v_add_f32 v101, v101, v109
    v_cvt_pk_bf16_f32 v12, v100, v101
    buffer_store_dword v12, v3, s[32:35], 0 offen offset:512
    v_add_f32 v102, v102, v110
    v_add_f32 v103, v103, v111
    v_add_f32 v102, v102, v118
    v_add_f32 v103, v103, v119
    v_add_f32 v102, v102, v126
    v_add_f32 v103, v103, v127
    v_cvt_pk_bf16_f32 v102, v102, v103
    v_and_b32 v103, 0xffff0000, v102
    v_lshlrev_b32 v102, 16, v102
    v_mul_f32 v102, v102, v90
    v_mul_f32 v103, v103, v91
    v_cvt_pk_bf16_f32 v102, v102, v103
    v_and_b32 v103, 0xffff0000, v102
    v_lshlrev_b32 v102, 16, v102
    v_lshlrev_b32 v110, 16, v13
    v_and_b32 v111, 0xffff0000, v13
    v_add_f32 v102, v102, v110
    v_add_f32 v103, v103, v111
    v_cvt_pk_bf16_f32 v13, v102, v103
    buffer_store_dword v13, v3, s[32:35], 0 offen offset:768
    v_lshlrev_b32 v6, 3, v2
    s_mov_b32 s25, 8192
    s_mov_b32 s26, 6144
    buffer_load_dwordx2 v[60:61], v6, s[20:23], s25 offen offset:0
    buffer_load_dwordx2 v[76:77], v6, s[20:23], s26 offen offset:0
    buffer_load_dwordx2 v[62:63], v6, s[20:23], s25 offen offset:512
    buffer_load_dwordx2 v[78:79], v6, s[20:23], s26 offen offset:512
    buffer_load_dwordx2 v[64:65], v6, s[20:23], s25 offen offset:1024
    buffer_load_dwordx2 v[80:81], v6, s[20:23], s26 offen offset:1024
    buffer_load_dwordx2 v[66:67], v6, s[20:23], s25 offen offset:1536
    buffer_load_dwordx2 v[82:83], v6, s[20:23], s26 offen offset:1536
    v_xor_b32 v50, 1, v2
    v_lshlrev_b32 v50, 2, v50
    v_xor_b32 v51, 2, v2
    v_lshlrev_b32 v51, 2, v51
    v_xor_b32 v52, 4, v2
    v_lshlrev_b32 v52, 2, v52
    v_xor_b32 v53, 8, v2
    v_lshlrev_b32 v53, 2, v53
    v_xor_b32 v54, 16, v2
    v_lshlrev_b32 v54, 2, v54
    v_xor_b32 v55, 32, v2
    v_lshlrev_b32 v55, 2, v55
    v_lshlrev_b32 v20, 16, v10
    v_and_b32 v21, 0xffff0000, v10
    v_lshlrev_b32 v22, 16, v11
    v_and_b32 v23, 0xffff0000, v11
    v_lshlrev_b32 v24, 16, v12
    v_and_b32 v25, 0xffff0000, v12
    v_lshlrev_b32 v26, 16, v13
    v_and_b32 v27, 0xffff0000, v13
    v_add_f32 v7, v20, v21
    v_add_f32 v7, v7, v22
    v_add_f32 v7, v7, v23
    v_add_f32 v7, v7, v24
    v_add_f32 v7, v7, v25
    v_add_f32 v7, v7, v26
    v_add_f32 v7, v7, v27
    ds_bpermute_b32 v8, v50, v7
    s_waitcnt lgkmcnt(0)
    v_add_f32 v7, v7, v8
    ds_bpermute_b32 v8, v51, v7
    s_waitcnt lgkmcnt(0)
    v_add_f32 v7, v7, v8
    ds_bpermute_b32 v8, v52, v7
    s_waitcnt lgkmcnt(0)
    v_add_f32 v7, v7, v8
    ds_bpermute_b32 v8, v53, v7
    s_waitcnt lgkmcnt(0)
    v_add_f32 v7, v7, v8
    ds_bpermute_b32 v8, v54, v7
    s_waitcnt lgkmcnt(0)
    v_add_f32 v7, v7, v8
    ds_bpermute_b32 v8, v55, v7
    s_waitcnt lgkmcnt(0)
    v_add_f32 v7, v7, v8
    v_mul_f32 v7, 0.001953125, v7
    v_sub_f32 v20, v20, v7
    v_sub_f32 v21, v21, v7
    v_sub_f32 v22, v22, v7
    v_sub_f32 v23, v23, v7
    v_sub_f32 v24, v24, v7
    v_sub_f32 v25, v25, v7
    v_sub_f32 v26, v26, v7
    v_sub_f32 v27, v27, v7
    v_mul_f32 v9, v20, v20
    v_fmac_f32 v9, v21, v21
    v_fmac_f32 v9, v22, v22
    v_fmac_f32 v9, v23, v23
    v_fmac_f32 v9, v24, v24
    v_fmac_f32 v9, v25, v25
    v_fmac_f32 v9, v26, v26
    v_fmac_f32 v9, v27, v27
    ds_bpermute_b32 v8, v50, v9
    s_waitcnt lgkmcnt(0)
    v_add_f32 v9, v9, v8
    ds_bpermute_b32 v8, v51, v9
    s_waitcnt lgkmcnt(0)
    v_add_f32 v9, v9, v8
    ds_bpermute_b32 v8, v52, v9
    s_waitcnt lgkmcnt(0)
    v_add_f32 v9, v9, v8
    ds_bpermute_b32 v8, v53, v9
    s_waitcnt lgkmcnt(0)
    v_add_f32 v9, v9, v8
    ds_bpermute_b32 v8, v54, v9
    s_waitcnt lgkmcnt(0)
    v_add_f32 v9, v9, v8
    ds_bpermute_b32 v8, v55, v9
    s_waitcnt lgkmcnt(0)
    v_add_f32 v9, v9, v8
    v_mul_f32 v9, 0.001953125, v9
    v_add_f32 v9, 0x3727c5ac, v9
    v_rsq_f32 v9, v9
    s_nop 0
    s_waitcnt vmcnt(0)
    v_mul_f32 v20, v20, v9
    v_mul_f32 v21, v21, v9
    v_cvt_pk_bf16_f32 v20, v20, v21
    v_and_b32 v21, 0xffff0000, v20
    v_lshlrev_b32 v20, 16, v20
    v_add_f32 v60, 1.0, v60
    v_add_f32 v61, 1.0, v61
    v_cvt_pk_bf16_f32 v60, v60, v61
    v_and_b32 v61, 0xffff0000, v60
    v_lshlrev_b32 v60, 16, v60
    v_mul_f32 v20, v20, v60
    v_mul_f32 v21, v21, v61
    v_cvt_pk_bf16_f32 v20, v20, v21
    v_and_b32 v21, 0xffff0000, v20
    v_lshlrev_b32 v20, 16, v20
    v_add_f32 v20, v20, v76
    v_add_f32 v21, v21, v77
    v_cvt_pk_bf16_f32 v20, v20, v21
    buffer_store_dword v20, v5, s[16:19], 0 offen offset:0
    v_mul_f32 v22, v22, v9
    v_mul_f32 v23, v23, v9
    v_cvt_pk_bf16_f32 v22, v22, v23
    v_and_b32 v23, 0xffff0000, v22
    v_lshlrev_b32 v22, 16, v22
    v_add_f32 v62, 1.0, v62
    v_add_f32 v63, 1.0, v63
    v_cvt_pk_bf16_f32 v62, v62, v63
    v_and_b32 v63, 0xffff0000, v62
    v_lshlrev_b32 v62, 16, v62
    v_mul_f32 v22, v22, v62
    v_mul_f32 v23, v23, v63
    v_cvt_pk_bf16_f32 v22, v22, v23
    v_and_b32 v23, 0xffff0000, v22
    v_lshlrev_b32 v22, 16, v22
    v_add_f32 v22, v22, v78
    v_add_f32 v23, v23, v79
    v_cvt_pk_bf16_f32 v22, v22, v23
    buffer_store_dword v22, v5, s[16:19], 0 offen offset:256
    v_mul_f32 v24, v24, v9
    v_mul_f32 v25, v25, v9
    v_cvt_pk_bf16_f32 v24, v24, v25
    v_and_b32 v25, 0xffff0000, v24
    v_lshlrev_b32 v24, 16, v24
    v_add_f32 v64, 1.0, v64
    v_add_f32 v65, 1.0, v65
    v_cvt_pk_bf16_f32 v64, v64, v65
    v_and_b32 v65, 0xffff0000, v64
    v_lshlrev_b32 v64, 16, v64
    v_mul_f32 v24, v24, v64
    v_mul_f32 v25, v25, v65
    v_cvt_pk_bf16_f32 v24, v24, v25
    v_and_b32 v25, 0xffff0000, v24
    v_lshlrev_b32 v24, 16, v24
    v_add_f32 v24, v24, v80
    v_add_f32 v25, v25, v81
    v_cvt_pk_bf16_f32 v24, v24, v25
    buffer_store_dword v24, v5, s[16:19], 0 offen offset:512
    v_mul_f32 v26, v26, v9
    v_mul_f32 v27, v27, v9
    v_cvt_pk_bf16_f32 v26, v26, v27
    v_and_b32 v27, 0xffff0000, v26
    v_lshlrev_b32 v26, 16, v26
    v_add_f32 v66, 1.0, v66
    v_add_f32 v67, 1.0, v67
    v_cvt_pk_bf16_f32 v66, v66, v67
    v_and_b32 v67, 0xffff0000, v66
    v_lshlrev_b32 v66, 16, v66
    v_mul_f32 v26, v26, v66
    v_mul_f32 v27, v27, v67
    v_cvt_pk_bf16_f32 v26, v26, v27
    v_and_b32 v27, 0xffff0000, v26
    v_lshlrev_b32 v26, 16, v26
    v_add_f32 v26, v26, v82
    v_add_f32 v27, v27, v83
    v_cvt_pk_bf16_f32 v26, v26, v27
    buffer_store_dword v26, v5, s[16:19], 0 offen offset:768
ln2_done1:
    s_endpgm
.globl win_kernel
.p2align 8
.type win_kernel,@function
win_kernel:
    s_cmp_ge_u32 s2, 224
    s_cbranch_scc1 win_done1
    s_load_dwordx2 s[28:29], s[0:1], 112
    s_load_dwordx2 s[40:41], s[0:1], 48
    s_waitcnt lgkmcnt(0)
    s_add_u32 s8, s28, 52428800
    s_addc_u32 s9, s29, 0
    s_and_b32 s9, s9, 0xffff
    s_mov_b32 s10, 2097152
    s_mov_b32 s11, 0x20000
    s_mov_b32 s12, s40
    s_mov_b32 s13, s41
    s_and_b32 s13, s13, 0xffff
    s_mov_b32 s14, 1835008
    s_mov_b32 s15, 0x20000
    s_add_u32 s16, s28, 54525952
    s_addc_u32 s17, s29, 0
    s_and_b32 s17, s17, 0xffff
    s_mov_b32 s18, 7340032
    s_mov_b32 s19, 0x20000
    s_and_b32 s39, s2, 0
    s_lshr_b32 s2, s2, 0
    s_mov_b32 s30, 306783379
    s_mul_hi_u32 s31, s2, s30
    s_mul_i32 s32, s31, 14
    s_sub_u32 s32, s2, s32
    s_mul_i32 s33, s31, 128
    s_mul_i32 s34, s32, 128
    v_lshrrev_b32 v1, 6, v0
    v_and_b32 v2, 63, v0
    v_readfirstlane_b32 s35, v1
    s_nop 3
    v_lshrrev_b32 v6, 3, v2
    s_mul_i32 s36, s35, 32
    s_add_u32 s36, s36, s33
    v_add_u32 v6, s36, v6
    v_mul_u32_u24 v6, 1024, v6
    v_lshrrev_b32 v7, 4, v2
    v_and_b32 v8, 7, v2
    v_add_u32 v9, 0, v7
    v_and_b32 v9, 7, v9
    v_xor_b32 v9, v9, v8
    v_lshlrev_b32 v9, 4, v9
    v_add_u32 v3, v6, v9
    v_add_u32 v9, 4, v7
    v_and_b32 v9, 7, v9
    v_xor_b32 v9, v9, v8
    v_lshlrev_b32 v9, 4, v9
    v_add_u32 v4, v6, v9
    v_lshrrev_b32 v6, 4, v2
    v_and_b32 v8, 15, v2
    v_lshlrev_b32 v9, 2, v6
    v_xor_b32 v9, v9, v8
    s_mul_i32 s36, s35, 16
    v_add_u32 v6, s36, v6
    v_mul_u32_u24 v6, 3584, v6
    v_lshlrev_b32 v9, 4, v9
    v_add_u32 v6, v6, v9
    s_lshl_b32 s36, s34, 1
    v_add_u32 v5, s36, v6
    s_lshr_b32 s37, s35, 1
    s_and_b32 s38, s35, 1
    v_and_b32 v6, 31, v2
    v_lshrrev_b32 v7, 5, v2
    s_mul_i32 s36, s37, 64
    v_add_u32 v8, s36, v6
    v_lshrrev_b32 v9, 1, v8
    v_and_b32 v9, 7, v9
    v_xor_b32 v9, v9, v7
    v_lshlrev_b32 v9, 4, v9
    v_lshlrev_b32 v8, 7, v8
    v_add_u32 v10, v8, v9
    v_xor_b32 v11, 32, v10
    v_xor_b32 v12, 64, v10
    v_xor_b32 v13, 96, v10
    v_lshrrev_b32 v6, 4, v2
    v_and_b32 v7, 15, v2
    v_lshrrev_b32 v8, 1, v6
    v_lshlrev_b32 v8, 3, v8
    v_lshrrev_b32 v9, 2, v7
    v_add_u32 v8, v8, v9
    v_mul_u32_u24 v8, 256, v8
    v_and_b32 v6, 1, v6
    v_lshlrev_b32 v6, 1, v6
    v_and_b32 v16, 3, v7
    v_lshrrev_b32 v16, 1, v16
    v_add_u32 v6, v6, v16
    s_mul_i32 s36, s38, 8
    v_add_u32 v6, s36, v6
    v_lshlrev_b32 v9, 2, v9
    v_and_b32 v16, 1, v7
    v_lshlrev_b32 v16, 3, v16
    v_add_u32 v8, v8, v16
    v_add_u32 v16, 0, v6
    v_xor_b32 v16, v16, v9
    v_lshlrev_b32 v16, 4, v16
    v_add_u32 v14, v8, v16
    v_add_u32 v14, 16384, v14
    v_add_u32 v16, 4, v6
    v_xor_b32 v16, v16, v9
    v_lshlrev_b32 v16, 4, v16
    v_add_u32 v15, v8, v16
    v_add_u32 v15, 16384, v15
    v_add_u32 v20, 0x10000, v10
    v_add_u32 v21, 0x10000, v11
    v_add_u32 v22, 0x10000, v12
    v_add_u32 v23, 0x10000, v13
    v_add_u32 v24, 0x10000, v14
    v_add_u32 v25, 0x10000, v15
    v_mov_b32 v60, 0
    v_mov_b32 v61, 0
    v_mov_b32 v62, 0
    v_mov_b32 v63, 0
    v_mov_b32 v64, 0
    v_mov_b32 v65, 0
    v_mov_b32 v66, 0
    v_mov_b32 v67, 0
    v_mov_b32 v68, 0
    v_mov_b32 v69, 0
    v_mov_b32 v70, 0
    v_mov_b32 v71, 0
    v_mov_b32 v72, 0
    v_mov_b32 v73, 0
    v_mov_b32 v74, 0
    v_mov_b32 v75, 0
    v_mov_b32 v76, 0
    v_mov_b32 v77, 0
    v_mov_b32 v78, 0
    v_mov_b32 v79, 0
    v_mov_b32 v80, 0
    v_mov_b32 v81, 0
    v_mov_b32 v82, 0
    v_mov_b32 v83, 0
    v_mov_b32 v84, 0
    v_mov_b32 v85, 0
    v_mov_b32 v86, 0
    v_mov_b32 v87, 0
    v_mov_b32 v88, 0
    v_mov_b32 v89, 0
    v_mov_b32 v90, 0
    v_mov_b32 v91, 0
    v_mov_b32 v92, 0
    v_mov_b32 v93, 0
    v_mov_b32 v94, 0
    v_mov_b32 v95, 0
    v_mov_b32 v96, 0
    v_mov_b32 v97, 0
    v_mov_b32 v98, 0
    v_mov_b32 v99, 0
    v_mov_b32 v100, 0
    v_mov_b32 v101, 0
    v_mov_b32 v102, 0
    v_mov_b32 v103, 0
    v_mov_b32 v104, 0
    v_mov_b32 v105, 0
    v_mov_b32 v106, 0
    v_mov_b32 v107, 0
    v_mov_b32 v108, 0
    v_mov_b32 v109, 0
    v_mov_b32 v110, 0
    v_mov_b32 v111, 0
    v_mov_b32 v112, 0
    v_mov_b32 v113, 0
    v_mov_b32 v114, 0
    v_mov_b32 v115, 0
    v_mov_b32 v116, 0
    v_mov_b32 v117, 0
    v_mov_b32 v118, 0
    v_mov_b32 v119, 0
    v_mov_b32 v120, 0
    v_mov_b32 v121, 0
    v_mov_b32 v122, 0
    v_mov_b32 v123, 0
    s_mul_i32 s40, s39, 1024
    s_mul_i32 s41, s39, 1835008
    s_mul_i32 s36, s35, 4096
    s_add_u32 m0, s36, 0
    s_add_u32 s36, s40, 0
    buffer_load_dwordx4 v3, s[8:11], s36 offen lds
    s_mul_i32 s36, s35, 4096
    s_add_u32 m0, s36, 1024
    s_add_u32 s36, s40, 8192
    buffer_load_dwordx4 v4, s[8:11], s36 offen lds
    s_mul_i32 s36, s35, 4096
    s_add_u32 m0, s36, 2048
    s_add_u32 s36, s40, 16384
    buffer_load_dwordx4 v3, s[8:11], s36 offen lds
    s_mul_i32 s36, s35, 4096
    s_add_u32 m0, s36, 3072
    s_add_u32 s36, s40, 24576
    buffer_load_dwordx4 v4, s[8:11], s36 offen lds
    s_mul_i32 s36, s35, 4096
    s_add_u32 m0, s36, 16384
    s_add_u32 s36, s41, 0
    buffer_load_dwordx4 v5, s[12:15], s36 offen lds
    s_mul_i32 s36, s35, 4096
    s_add_u32 m0, s36, 17408
    s_add_u32 s36, s41, 14336
    buffer_load_dwordx4 v5, s[12:15], s36 offen lds
    s_mul_i32 s36, s35, 4096
    s_add_u32 m0, s36, 18432
    s_add_u32 s36, s41, 28672
    buffer_load_dwordx4 v5, s[12:15], s36 offen lds
    s_mul_i32 s36, s35, 4096
    s_add_u32 m0, s36, 19456
    s_add_u32 s36, s41, 43008
    buffer_load_dwordx4 v5, s[12:15], s36 offen lds
    s_add_u32 s40, s40, 128
    s_add_u32 s41, s41, 229376
    s_mul_i32 s36, s35, 4096
    s_add_u32 m0, s36, 32768
    s_add_u32 s36, s40, 0
    buffer_load_dwordx4 v3, s[8:11], s36 offen lds
    s_mul_i32 s36, s35, 4096
    s_add_u32 m0, s36, 33792
    s_add_u32 s36, s40, 8192
    buffer_load_dwordx4 v4, s[8:11], s36 offen lds
    s_mul_i32 s36, s35, 4096
    s_add_u32 m0, s36, 34816
    s_add_u32 s36, s40, 16384
    buffer_load_dwordx4 v3, s[8:11], s36 offen lds
    s_mul_i32 s36, s35, 4096
    s_add_u32 m0, s36, 35840
    s_add_u32 s36, s40, 24576
    buffer_load_dwordx4 v4, s[8:11], s36 offen lds
    s_mul_i32 s36, s35, 4096
    s_add_u32 m0, s36, 49152
    s_add_u32 s36, s41, 0
    buffer_load_dwordx4 v5, s[12:15], s36 offen lds
    s_mul_i32 s36, s35, 4096
    s_add_u32 m0, s36, 50176
    s_add_u32 s36, s41, 14336
    buffer_load_dwordx4 v5, s[12:15], s36 offen lds
    s_mul_i32 s36, s35, 4096
    s_add_u32 m0, s36, 51200
    s_add_u32 s36, s41, 28672
    buffer_load_dwordx4 v5, s[12:15], s36 offen lds
    s_mul_i32 s36, s35, 4096
    s_add_u32 m0, s36, 52224
    s_add_u32 s36, s41, 43008
    buffer_load_dwordx4 v5, s[12:15], s36 offen lds
    s_add_u32 s40, s40, 128
    s_add_u32 s41, s41, 229376
    s_mov_b32 s42, 2
win_loop2:
    s_waitcnt vmcnt(8)
    s_barrier
    s_mul_i32 s36, s35, 4096
    s_add_u32 m0, s36, 65536
    s_add_u32 s36, s40, 0
    buffer_load_dwordx4 v3, s[8:11], s36 offen lds
    s_mul_i32 s36, s35, 4096
    s_add_u32 m0, s36, 66560
    s_add_u32 s36, s40, 8192
    buffer_load_dwordx4 v4, s[8:11], s36 offen lds
    s_mul_i32 s36, s35, 4096
    s_add_u32 m0, s36, 67584
    s_add_u32 s36, s40, 16384
    buffer_load_dwordx4 v3, s[8:11], s36 offen lds
    s_mul_i32 s36, s35, 4096
    s_add_u32 m0, s36, 68608
    s_add_u32 s36, s40, 24576
    buffer_load_dwordx4 v4, s[8:11], s36 offen lds
    s_mul_i32 s36, s35, 4096
    s_add_u32 m0, s36, 81920
    s_add_u32 s36, s41, 0
    buffer_load_dwordx4 v5, s[12:15], s36 offen lds
    s_mul_i32 s36, s35, 4096
    s_add_u32 m0, s36, 82944
    s_add_u32 s36, s41, 14336
    buffer_load_dwordx4 v5, s[12:15], s36 offen lds
    s_mul_i32 s36, s35, 4096
    s_add_u32 m0, s36, 83968
    s_add_u32 s36, s41, 28672
    buffer_load_dwordx4 v5, s[12:15], s36 offen lds
    s_mul_i32 s36, s35, 4096
    s_add_u32 m0, s36, 84992
    s_add_u32 s36, s41, 43008
    buffer_load_dwordx4 v5, s[12:15], s36 offen lds
    s_add_u32 s40, s40, 128
    s_add_u32 s41, s41, 229376
    ds_read_b128 v[28:31], v10 offset:0
    ds_read_b128 v[32:35], v10 offset:4096
    ds_read_b64_tr_b16 v[36:37], v14 offset:0
    ds_read_b64_tr_b16 v[38:39], v14 offset:1024
    ds_read_b64_tr_b16 v[40:41], v15 offset:0
    ds_read_b64_tr_b16 v[42:43], v15 offset:1024
    ds_read_b128 v[44:47], v11 offset:0
    ds_read_b128 v[48:51], v11 offset:4096
    ds_read_b64_tr_b16 v[52:53], v14 offset:4096
    ds_read_b64_tr_b16 v[54:55], v14 offset:5120
    ds_read_b64_tr_b16 v[56:57], v15 offset:4096
    ds_read_b64_tr_b16 v[58:59], v15 offset:5120
    s_waitcnt lgkmcnt(6)
    v_mfma_f32_32x32x16_bf16 v[60:75], v[36:39], v[28:31], v[60:75]
    v_mfma_f32_32x32x16_bf16 v[76:91], v[40:43], v[28:31], v[76:91]
    v_mfma_f32_32x32x16_bf16 v[92:107], v[36:39], v[32:35], v[92:107]
    v_mfma_f32_32x32x16_bf16 v[108:123], v[40:43], v[32:35], v[108:123]
    ds_read_b128 v[28:31], v12 offset:0
    ds_read_b128 v[32:35], v12 offset:4096
    ds_read_b64_tr_b16 v[36:37], v14 offset:8192
    ds_read_b64_tr_b16 v[38:39], v14 offset:9216
    ds_read_b64_tr_b16 v[40:41], v15 offset:8192
    ds_read_b64_tr_b16 v[42:43], v15 offset:9216
    s_waitcnt lgkmcnt(6)
    v_mfma_f32_32x32x16_bf16 v[60:75], v[52:55], v[44:47], v[60:75]
    v_mfma_f32_32x32x16_bf16 v[76:91], v[56:59], v[44:47], v[76:91]
    v_mfma_f32_32x32x16_bf16 v[92:107], v[52:55], v[48:51], v[92:107]
    v_mfma_f32_32x32x16_bf16 v[108:123], v[56:59], v[48:51], v[108:123]
    ds_read_b128 v[44:47], v13 offset:0
    ds_read_b128 v[48:51], v13 offset:4096
    ds_read_b64_tr_b16 v[52:53], v14 offset:12288
    ds_read_b64_tr_b16 v[54:55], v14 offset:13312
    ds_read_b64_tr_b16 v[56:57], v15 offset:12288
    ds_read_b64_tr_b16 v[58:59], v15 offset:13312
    s_waitcnt lgkmcnt(6)
    v_mfma_f32_32x32x16_bf16 v[60:75], v[36:39], v[28:31], v[60:75]
    v_mfma_f32_32x32x16_bf16 v[76:91], v[40:43], v[28:31], v[76:91]
    v_mfma_f32_32x32x16_bf16 v[92:107], v[36:39], v[32:35], v[92:107]
    v_mfma_f32_32x32x16_bf16 v[108:123], v[40:43], v[32:35], v[108:123]
    s_waitcnt lgkmcnt(0)
    v_mfma_f32_32x32x16_bf16 v[60:75], v[52:55], v[44:47], v[60:75]
    v_mfma_f32_32x32x16_bf16 v[76:91], v[56:59], v[44:47], v[76:91]
    v_mfma_f32_32x32x16_bf16 v[92:107], v[52:55], v[48:51], v[92:107]
    v_mfma_f32_32x32x16_bf16 v[108:123], v[56:59], v[48:51], v[108:123]
    s_waitcnt vmcnt(8)
    s_barrier
    s_mul_i32 s36, s35, 4096
    s_add_u32 m0, s36, 0
    s_add_u32 s36, s40, 0
    buffer_load_dwordx4 v3, s[8:11], s36 offen lds
    s_mul_i32 s36, s35, 4096
    s_add_u32 m0, s36, 1024
    s_add_u32 s36, s40, 8192
    buffer_load_dwordx4 v4, s[8:11], s36 offen lds
    s_mul_i32 s36, s35, 4096
    s_add_u32 m0, s36, 2048
    s_add_u32 s36, s40, 16384
    buffer_load_dwordx4 v3, s[8:11], s36 offen lds
    s_mul_i32 s36, s35, 4096
    s_add_u32 m0, s36, 3072
    s_add_u32 s36, s40, 24576
    buffer_load_dwordx4 v4, s[8:11], s36 offen lds
    s_mul_i32 s36, s35, 4096
    s_add_u32 m0, s36, 16384
    s_add_u32 s36, s41, 0
    buffer_load_dwordx4 v5, s[12:15], s36 offen lds
    s_mul_i32 s36, s35, 4096
    s_add_u32 m0, s36, 17408
    s_add_u32 s36, s41, 14336
    buffer_load_dwordx4 v5, s[12:15], s36 offen lds
    s_mul_i32 s36, s35, 4096
    s_add_u32 m0, s36, 18432
    s_add_u32 s36, s41, 28672
    buffer_load_dwordx4 v5, s[12:15], s36 offen lds
    s_mul_i32 s36, s35, 4096
    s_add_u32 m0, s36, 19456
    s_add_u32 s36, s41, 43008
    buffer_load_dwordx4 v5, s[12:15], s36 offen lds
    s_add_u32 s40, s40, 128
    s_add_u32 s41, s41, 229376
    ds_read_b128 v[28:31], v10 offset:32768
    ds_read_b128 v[32:35], v10 offset:36864
    ds_read_b64_tr_b16 v[36:37], v14 offset:32768
    ds_read_b64_tr_b16 v[38:39], v14 offset:33792
    ds_read_b64_tr_b16 v[40:41], v15 offset:32768
    ds_read_b64_tr_b16 v[42:43], v15 offset:33792
    ds_read_b128 v[44:47], v11 offset:32768
    ds_read_b128 v[48:51], v11 offset:36864
    ds_read_b64_tr_b16 v[52:53], v14 offset:36864
    ds_read_b64_tr_b16 v[54:55], v14 offset:37888
    ds_read_b64_tr_b16 v[56:57], v15 offset:36864
    ds_read_b64_tr_b16 v[58:59], v15 offset:37888
    s_waitcnt lgkmcnt(6)
    v_mfma_f32_32x32x16_bf16 v[60:75], v[36:39], v[28:31], v[60:75]
    v_mfma_f32_32x32x16_bf16 v[76:91], v[40:43], v[28:31], v[76:91]
    v_mfma_f32_32x32x16_bf16 v[92:107], v[36:39], v[32:35], v[92:107]
    v_mfma_f32_32x32x16_bf16 v[108:123], v[40:43], v[32:35], v[108:123]
    ds_read_b128 v[28:31], v12 offset:32768
    ds_read_b128 v[32:35], v12 offset:36864
    ds_read_b64_tr_b16 v[36:37], v14 offset:40960
    ds_read_b64_tr_b16 v[38:39], v14 offset:41984
    ds_read_b64_tr_b16 v[40:41], v15 offset:40960
    ds_read_b64_tr_b16 v[42:43], v15 offset:41984
    s_waitcnt lgkmcnt(6)
    v_mfma_f32_32x32x16_bf16 v[60:75], v[52:55], v[44:47], v[60:75]
    v_mfma_f32_32x32x16_bf16 v[76:91], v[56:59], v[44:47], v[76:91]
    v_mfma_f32_32x32x16_bf16 v[92:107], v[52:55], v[48:51], v[92:107]
    v_mfma_f32_32x32x16_bf16 v[108:123], v[56:59], v[48:51], v[108:123]
    ds_read_b128 v[44:47], v13 offset:32768
    ds_read_b128 v[48:51], v13 offset:36864
    ds_read_b64_tr_b16 v[52:53], v14 offset:45056
    ds_read_b64_tr_b16 v[54:55], v14 offset:46080
    ds_read_b64_tr_b16 v[56:57], v15 offset:45056
    ds_read_b64_tr_b16 v[58:59], v15 offset:46080
    s_waitcnt lgkmcnt(6)
    v_mfma_f32_32x32x16_bf16 v[60:75], v[36:39], v[28:31], v[60:75]
    v_mfma_f32_32x32x16_bf16 v[76:91], v[40:43], v[28:31], v[76:91]
    v_mfma_f32_32x32x16_bf16 v[92:107], v[36:39], v[32:35], v[92:107]
    v_mfma_f32_32x32x16_bf16 v[108:123], v[40:43], v[32:35], v[108:123]
    s_waitcnt lgkmcnt(0)
    v_mfma_f32_32x32x16_bf16 v[60:75], v[52:55], v[44:47], v[60:75]
    v_mfma_f32_32x32x16_bf16 v[76:91], v[56:59], v[44:47], v[76:91]
    v_mfma_f32_32x32x16_bf16 v[92:107], v[52:55], v[48:51], v[92:107]
    v_mfma_f32_32x32x16_bf16 v[108:123], v[56:59], v[48:51], v[108:123]
    s_waitcnt vmcnt(8)
    s_barrier
    s_mul_i32 s36, s35, 4096
    s_add_u32 m0, s36, 32768
    s_add_u32 s36, s40, 0
    buffer_load_dwordx4 v3, s[8:11], s36 offen lds
    s_mul_i32 s36, s35, 4096
    s_add_u32 m0, s36, 33792
    s_add_u32 s36, s40, 8192
    buffer_load_dwordx4 v4, s[8:11], s36 offen lds
    s_mul_i32 s36, s35, 4096
    s_add_u32 m0, s36, 34816
    s_add_u32 s36, s40, 16384
    buffer_load_dwordx4 v3, s[8:11], s36 offen lds
    s_mul_i32 s36, s35, 4096
    s_add_u32 m0, s36, 35840
    s_add_u32 s36, s40, 24576
    buffer_load_dwordx4 v4, s[8:11], s36 offen lds
    s_mul_i32 s36, s35, 4096
    s_add_u32 m0, s36, 49152
    s_add_u32 s36, s41, 0
    buffer_load_dwordx4 v5, s[12:15], s36 offen lds
    s_mul_i32 s36, s35, 4096
    s_add_u32 m0, s36, 50176
    s_add_u32 s36, s41, 14336
    buffer_load_dwordx4 v5, s[12:15], s36 offen lds
    s_mul_i32 s36, s35, 4096
    s_add_u32 m0, s36, 51200
    s_add_u32 s36, s41, 28672
    buffer_load_dwordx4 v5, s[12:15], s36 offen lds
    s_mul_i32 s36, s35, 4096
    s_add_u32 m0, s36, 52224
    s_add_u32 s36, s41, 43008
    buffer_load_dwordx4 v5, s[12:15], s36 offen lds
    s_add_u32 s40, s40, 128
    s_add_u32 s41, s41, 229376
    ds_read_b128 v[28:31], v20 offset:0
    ds_read_b128 v[32:35], v20 offset:4096
    ds_read_b64_tr_b16 v[36:37], v24 offset:0
    ds_read_b64_tr_b16 v[38:39], v24 offset:1024
    ds_read_b64_tr_b16 v[40:41], v25 offset:0
    ds_read_b64_tr_b16 v[42:43], v25 offset:1024
    ds_read_b128 v[44:47], v21 offset:0
    ds_read_b128 v[48:51], v21 offset:4096
    ds_read_b64_tr_b16 v[52:53], v24 offset:4096
    ds_read_b64_tr_b16 v[54:55], v24 offset:5120
    ds_read_b64_tr_b16 v[56:57], v25 offset:4096
    ds_read_b64_tr_b16 v[58:59], v25 offset:5120
    s_waitcnt lgkmcnt(6)
    v_mfma_f32_32x32x16_bf16 v[60:75], v[36:39], v[28:31], v[60:75]
    v_mfma_f32_32x32x16_bf16 v[76:91], v[40:43], v[28:31], v[76:91]
    v_mfma_f32_32x32x16_bf16 v[92:107], v[36:39], v[32:35], v[92:107]
    v_mfma_f32_32x32x16_bf16 v[108:123], v[40:43], v[32:35], v[108:123]
    ds_read_b128 v[28:31], v22 offset:0
    ds_read_b128 v[32:35], v22 offset:4096
    ds_read_b64_tr_b16 v[36:37], v24 offset:8192
    ds_read_b64_tr_b16 v[38:39], v24 offset:9216
    ds_read_b64_tr_b16 v[40:41], v25 offset:8192
    ds_read_b64_tr_b16 v[42:43], v25 offset:9216
    s_waitcnt lgkmcnt(6)
    v_mfma_f32_32x32x16_bf16 v[60:75], v[52:55], v[44:47], v[60:75]
    v_mfma_f32_32x32x16_bf16 v[76:91], v[56:59], v[44:47], v[76:91]
    v_mfma_f32_32x32x16_bf16 v[92:107], v[52:55], v[48:51], v[92:107]
    v_mfma_f32_32x32x16_bf16 v[108:123], v[56:59], v[48:51], v[108:123]
    ds_read_b128 v[44:47], v23 offset:0
    ds_read_b128 v[48:51], v23 offset:4096
    ds_read_b64_tr_b16 v[52:53], v24 offset:12288
    ds_read_b64_tr_b16 v[54:55], v24 offset:13312
    ds_read_b64_tr_b16 v[56:57], v25 offset:12288
    ds_read_b64_tr_b16 v[58:59], v25 offset:13312
    s_waitcnt lgkmcnt(6)
    v_mfma_f32_32x32x16_bf16 v[60:75], v[36:39], v[28:31], v[60:75]
    v_mfma_f32_32x32x16_bf16 v[76:91], v[40:43], v[28:31], v[76:91]
    v_mfma_f32_32x32x16_bf16 v[92:107], v[36:39], v[32:35], v[92:107]
    v_mfma_f32_32x32x16_bf16 v[108:123], v[40:43], v[32:35], v[108:123]
    s_waitcnt lgkmcnt(0)
    v_mfma_f32_32x32x16_bf16 v[60:75], v[52:55], v[44:47], v[60:75]
    v_mfma_f32_32x32x16_bf16 v[76:91], v[56:59], v[44:47], v[76:91]
    v_mfma_f32_32x32x16_bf16 v[92:107], v[52:55], v[48:51], v[92:107]
    v_mfma_f32_32x32x16_bf16 v[108:123], v[56:59], v[48:51], v[108:123]
    s_sub_u32 s42, s42, 1
    s_cmp_lg_u32 s42, 0
    s_cbranch_scc1 win_loop2
    s_waitcnt vmcnt(8)
    s_barrier
    ds_read_b128 v[28:31], v10 offset:0
    ds_read_b128 v[32:35], v10 offset:4096
    ds_read_b64_tr_b16 v[36:37], v14 offset:0
    ds_read_b64_tr_b16 v[38:39], v14 offset:1024
    ds_read_b64_tr_b16 v[40:41], v15 offset:0
    ds_read_b64_tr_b16 v[42:43], v15 offset:1024
    ds_read_b128 v[44:47], v11 offset:0
    ds_read_b128 v[48:51], v11 offset:4096
    ds_read_b64_tr_b16 v[52:53], v14 offset:4096
    ds_read_b64_tr_b16 v[54:55], v14 offset:5120
    ds_read_b64_tr_b16 v[56:57], v15 offset:4096
    ds_read_b64_tr_b16 v[58:59], v15 offset:5120
    s_waitcnt lgkmcnt(6)
    v_mfma_f32_32x32x16_bf16 v[60:75], v[36:39], v[28:31], v[60:75]
    v_mfma_f32_32x32x16_bf16 v[76:91], v[40:43], v[28:31], v[76:91]
    v_mfma_f32_32x32x16_bf16 v[92:107], v[36:39], v[32:35], v[92:107]
    v_mfma_f32_32x32x16_bf16 v[108:123], v[40:43], v[32:35], v[108:123]
    ds_read_b128 v[28:31], v12 offset:0
    ds_read_b128 v[32:35], v12 offset:4096
    ds_read_b64_tr_b16 v[36:37], v14 offset:8192
    ds_read_b64_tr_b16 v[38:39], v14 offset:9216
    ds_read_b64_tr_b16 v[40:41], v15 offset:8192
    ds_read_b64_tr_b16 v[42:43], v15 offset:9216
    s_waitcnt lgkmcnt(6)
    v_mfma_f32_32x32x16_bf16 v[60:75], v[52:55], v[44:47], v[60:75]
    v_mfma_f32_32x32x16_bf16 v[76:91], v[56:59], v[44:47], v[76:91]
    v_mfma_f32_32x32x16_bf16 v[92:107], v[52:55], v[48:51], v[92:107]
    v_mfma_f32_32x32x16_bf16 v[108:123], v[56:59], v[48:51], v[108:123]
    ds_read_b128 v[44:47], v13 offset:0
    ds_read_b128 v[48:51], v13 offset:4096
    ds_read_b64_tr_b16 v[52:53], v14 offset:12288
    ds_read_b64_tr_b16 v[54:55], v14 offset:13312
    ds_read_b64_tr_b16 v[56:57], v15 offset:12288
    ds_read_b64_tr_b16 v[58:59], v15 offset:13312
    s_waitcnt lgkmcnt(6)
    v_mfma_f32_32x32x16_bf16 v[60:75], v[36:39], v[28:31], v[60:75]
    v_mfma_f32_32x32x16_bf16 v[76:91], v[40:43], v[28:31], v[76:91]
    v_mfma_f32_32x32x16_bf16 v[92:107], v[36:39], v[32:35], v[92:107]
    v_mfma_f32_32x32x16_bf16 v[108:123], v[40:43], v[32:35], v[108:123]
    s_waitcnt lgkmcnt(0)
    v_mfma_f32_32x32x16_bf16 v[60:75], v[52:55], v[44:47], v[60:75]
    v_mfma_f32_32x32x16_bf16 v[76:91], v[56:59], v[44:47], v[76:91]
    v_mfma_f32_32x32x16_bf16 v[92:107], v[52:55], v[48:51], v[92:107]
    v_mfma_f32_32x32x16_bf16 v[108:123], v[56:59], v[48:51], v[108:123]
    s_waitcnt vmcnt(0)
    s_barrier
    ds_read_b128 v[28:31], v10 offset:32768
    ds_read_b128 v[32:35], v10 offset:36864
    ds_read_b64_tr_b16 v[36:37], v14 offset:32768
    ds_read_b64_tr_b16 v[38:39], v14 offset:33792
    ds_read_b64_tr_b16 v[40:41], v15 offset:32768
    ds_read_b64_tr_b16 v[42:43], v15 offset:33792
    ds_read_b128 v[44:47], v11 offset:32768
    ds_read_b128 v[48:51], v11 offset:36864
    ds_read_b64_tr_b16 v[52:53], v14 offset:36864
    ds_read_b64_tr_b16 v[54:55], v14 offset:37888
    ds_read_b64_tr_b16 v[56:57], v15 offset:36864
    ds_read_b64_tr_b16 v[58:59], v15 offset:37888
    s_waitcnt lgkmcnt(6)
    v_mfma_f32_32x32x16_bf16 v[60:75], v[36:39], v[28:31], v[60:75]
    v_mfma_f32_32x32x16_bf16 v[76:91], v[40:43], v[28:31], v[76:91]
    v_mfma_f32_32x32x16_bf16 v[92:107], v[36:39], v[32:35], v[92:107]
    v_mfma_f32_32x32x16_bf16 v[108:123], v[40:43], v[32:35], v[108:123]
    ds_read_b128 v[28:31], v12 offset:32768
    ds_read_b128 v[32:35], v12 offset:36864
    ds_read_b64_tr_b16 v[36:37], v14 offset:40960
    ds_read_b64_tr_b16 v[38:39], v14 offset:41984
    ds_read_b64_tr_b16 v[40:41], v15 offset:40960
    ds_read_b64_tr_b16 v[42:43], v15 offset:41984
    s_waitcnt lgkmcnt(6)
    v_mfma_f32_32x32x16_bf16 v[60:75], v[52:55], v[44:47], v[60:75]
    v_mfma_f32_32x32x16_bf16 v[76:91], v[56:59], v[44:47], v[76:91]
    v_mfma_f32_32x32x16_bf16 v[92:107], v[52:55], v[48:51], v[92:107]
    v_mfma_f32_32x32x16_bf16 v[108:123], v[56:59], v[48:51], v[108:123]
    ds_read_b128 v[44:47], v13 offset:32768
    ds_read_b128 v[48:51], v13 offset:36864
    ds_read_b64_tr_b16 v[52:53], v14 offset:45056
    ds_read_b64_tr_b16 v[54:55], v14 offset:46080
    ds_read_b64_tr_b16 v[56:57], v15 offset:45056
    ds_read_b64_tr_b16 v[58:59], v15 offset:46080
    s_waitcnt lgkmcnt(6)
    v_mfma_f32_32x32x16_bf16 v[60:75], v[36:39], v[28:31], v[60:75]
    v_mfma_f32_32x32x16_bf16 v[76:91], v[40:43], v[28:31], v[76:91]
    v_mfma_f32_32x32x16_bf16 v[92:107], v[36:39], v[32:35], v[92:107]
    v_mfma_f32_32x32x16_bf16 v[108:123], v[40:43], v[32:35], v[108:123]
    s_waitcnt lgkmcnt(0)
    v_mfma_f32_32x32x16_bf16 v[60:75], v[52:55], v[44:47], v[60:75]
    v_mfma_f32_32x32x16_bf16 v[76:91], v[56:59], v[44:47], v[76:91]
    v_mfma_f32_32x32x16_bf16 v[92:107], v[52:55], v[48:51], v[92:107]
    v_mfma_f32_32x32x16_bf16 v[108:123], v[56:59], v[48:51], v[108:123]
    s_nop 15
    s_nop 7
    s_barrier
    v_and_b32 v6, 31, v2
    v_mul_u32_u24 v6, 144, v6
    v_lshrrev_b32 v7, 5, v2
    v_lshlrev_b32 v7, 3, v7
    v_add_u32 v6, v6, v7
    s_mul_i32 s36, s35, 9216
    v_add_u32 v6, s36, v6
    v_cvt_pk_bf16_f32 v60, v60, v61
    v_cvt_pk_bf16_f32 v61, v62, v63
    ds_write_b64 v6, v[60:61] offset:0
    v_cvt_pk_bf16_f32 v64, v64, v65
    v_cvt_pk_bf16_f32 v65, v66, v67
    ds_write_b64 v6, v[64:65] offset:16
    v_cvt_pk_bf16_f32 v68, v68, v69
    v_cvt_pk_bf16_f32 v69, v70, v71
    ds_write_b64 v6, v[68:69] offset:32
    v_cvt_pk_bf16_f32 v72, v72, v73
    v_cvt_pk_bf16_f32 v73, v74, v75
    ds_write_b64 v6, v[72:73] offset:48
    v_cvt_pk_bf16_f32 v76, v76, v77
    v_cvt_pk_bf16_f32 v77, v78, v79
    ds_write_b64 v6, v[76:77] offset:64
    v_cvt_pk_bf16_f32 v80, v80, v81
    v_cvt_pk_bf16_f32 v81, v82, v83
    ds_write_b64 v6, v[80:81] offset:80
    v_cvt_pk_bf16_f32 v84, v84, v85
    v_cvt_pk_bf16_f32 v85, v86, v87
    ds_write_b64 v6, v[84:85] offset:96
    v_cvt_pk_bf16_f32 v88, v88, v89
    v_cvt_pk_bf16_f32 v89, v90, v91
    ds_write_b64 v6, v[88:89] offset:112
    v_cvt_pk_bf16_f32 v92, v92, v93
    v_cvt_pk_bf16_f32 v93, v94, v95
    ds_write_b64 v6, v[92:93] offset:4608
    v_cvt_pk_bf16_f32 v96, v96, v97
    v_cvt_pk_bf16_f32 v97, v98, v99
    ds_write_b64 v6, v[96:97] offset:4624
    v_cvt_pk_bf16_f32 v100, v100, v101
    v_cvt_pk_bf16_f32 v101, v102, v103
    ds_write_b64 v6, v[100:101] offset:4640
    v_cvt_pk_bf16_f32 v104, v104, v105
    v_cvt_pk_bf16_f32 v105, v106, v107
    ds_write_b64 v6, v[104:105] offset:4656
    v_cvt_pk_bf16_f32 v108, v108, v109
    v_cvt_pk_bf16_f32 v109, v110, v111
    ds_write_b64 v6, v[108:109] offset:4672
    v_cvt_pk_bf16_f32 v112, v112, v113
    v_cvt_pk_bf16_f32 v113, v114, v115
    ds_write_b64 v6, v[112:113] offset:4688
    v_cvt_pk_bf16_f32 v116, v116, v117
    v_cvt_pk_bf16_f32 v117, v118, v119
    ds_write_b64 v6, v[116:117] offset:4704
    v_cvt_pk_bf16_f32 v120, v120, v121
    v_cvt_pk_bf16_f32 v121, v122, v123
    ds_write_b64 v6, v[120:121] offset:4720
    v_lshrrev_b32 v8, 3, v2
    v_and_b32 v9, 7, v2
    v_mul_u32_u24 v6, 144, v8
    v_lshlrev_b32 v7, 4, v9
    v_add_u32 v6, v6, v7
    v_add_u32 v6, s36, v6
    s_mul_i32 s36, s37, 64
    s_add_u32 s36, s36, s33
    v_add_u32 v8, s36, v8
    v_lshlrev_b32 v9, 3, v9
    s_mul_i32 s36, s38, 64
    s_add_u32 s36, s36, s34
    v_add_u32 v9, s36, v9
    v_mul_u32_u24 v10, 3584, v8
    v_lshlrev_b32 v11, 1, v9
    v_add_u32 v10, v10, v11
    ds_read_b128 v[60:63], v6 offset:0
    ds_read_b128 v[72:75], v6 offset:1152
    ds_read_b128 v[84:87], v6 offset:2304
    ds_read_b128 v[96:99], v6 offset:3456
    s_waitcnt vmcnt(0) lgkmcnt(3)
    v_lshlrev_b32 v12, 16, v60
    v_and_b32 v13, 0xffff0000, v60
    v_mul_f32 v16, v12, v12
    v_mul_f32 v16, v16, v12
    v_mul_f32 v16, 0x3d372713, v16
    v_add_f32 v16, v16, v12
    v_mul_f32 v16, 0xc0135761, v16
    v_exp_f32 v16, v16
    s_nop 0
    v_add_f32 v16, 1.0, v16
    v_rcp_f32 v16, v16
    s_nop 0
    v_mul_f32 v12, v12, v16
    v_mul_f32 v16, v13, v13
    v_mul_f32 v16, v16, v13
    v_mul_f32 v16, 0x3d372713, v16
    v_add_f32 v16, v16, v13
    v_mul_f32 v16, 0xc0135761, v16
    v_exp_f32 v16, v16
    s_nop 0
    v_add_f32 v16, 1.0, v16
    v_rcp_f32 v16, v16
    s_nop 0
    v_mul_f32 v13, v13, v16
    v_cvt_pk_bf16_f32 v60, v12, v13
    v_lshlrev_b32 v12, 16, v61
    v_and_b32 v13, 0xffff0000, v61
    v_mul_f32 v16, v12, v12
    v_mul_f32 v16, v16, v12
    v_mul_f32 v16, 0x3d372713, v16
    v_add_f32 v16, v16, v12
    v_mul_f32 v16, 0xc0135761, v16
    v_exp_f32 v16, v16
    s_nop 0
    v_add_f32 v16, 1.0, v16
    v_rcp_f32 v16, v16
    s_nop 0
    v_mul_f32 v12, v12, v16
    v_mul_f32 v16, v13, v13
    v_mul_f32 v16, v16, v13
    v_mul_f32 v16, 0x3d372713, v16
    v_add_f32 v16, v16, v13
    v_mul_f32 v16, 0xc0135761, v16
    v_exp_f32 v16, v16
    s_nop 0
    v_add_f32 v16, 1.0, v16
    v_rcp_f32 v16, v16
    s_nop 0
    v_mul_f32 v13, v13, v16
    v_cvt_pk_bf16_f32 v61, v12, v13
    v_lshlrev_b32 v12, 16, v62
    v_and_b32 v13, 0xffff0000, v62
    v_mul_f32 v16, v12, v12
    v_mul_f32 v16, v16, v12
    v_mul_f32 v16, 0x3d372713, v16
    v_add_f32 v16, v16, v12
    v_mul_f32 v16, 0xc0135761, v16
    v_exp_f32 v16, v16
    s_nop 0
    v_add_f32 v16, 1.0, v16
    v_rcp_f32 v16, v16
    s_nop 0
    v_mul_f32 v12, v12, v16
    v_mul_f32 v16, v13, v13
    v_mul_f32 v16, v16, v13
    v_mul_f32 v16, 0x3d372713, v16
    v_add_f32 v16, v16, v13
    v_mul_f32 v16, 0xc0135761, v16
    v_exp_f32 v16, v16
    s_nop 0
    v_add_f32 v16, 1.0, v16
    v_rcp_f32 v16, v16
    s_nop 0
    v_mul_f32 v13, v13, v16
    v_cvt_pk_bf16_f32 v62, v12, v13
    v_lshlrev_b32 v12, 16, v63
    v_and_b32 v13, 0xffff0000, v63
    v_mul_f32 v16, v12, v12
    v_mul_f32 v16, v16, v12
    v_mul_f32 v16, 0x3d372713, v16
    v_add_f32 v16, v16, v12
    v_mul_f32 v16, 0xc0135761, v16
    v_exp_f32 v16, v16
    s_nop 0
    v_add_f32 v16, 1.0, v16
    v_rcp_f32 v16, v16
    s_nop 0
    v_mul_f32 v12, v12, v16
    v_mul_f32 v16, v13, v13
    v_mul_f32 v16, v16, v13
    v_mul_f32 v16, 0x3d372713, v16
    v_add_f32 v16, v16, v13
    v_mul_f32 v16, 0xc0135761, v16
    v_exp_f32 v16, v16
    s_nop 0
    v_add_f32 v16, 1.0, v16
    v_rcp_f32 v16, v16
    s_nop 0
    v_mul_f32 v13, v13, v16
    v_cvt_pk_bf16_f32 v63, v12, v13
    s_mov_b32 s36, 0
    buffer_store_dwordx4 v[60:63], v10, s[16:19], s36 offen
    s_waitcnt vmcnt(1) lgkmcnt(2)
    v_lshlrev_b32 v12, 16, v72
    v_and_b32 v13, 0xffff0000, v72
    v_mul_f32 v16, v12, v12
    v_mul_f32 v16, v16, v12
    v_mul_f32 v16, 0x3d372713, v16
    v_add_f32 v16, v16, v12
    v_mul_f32 v16, 0xc0135761, v16
    v_exp_f32 v16, v16
    s_nop 0
    v_add_f32 v16, 1.0, v16
    v_rcp_f32 v16, v16
    s_nop 0
    v_mul_f32 v12, v12, v16
    v_mul_f32 v16, v13, v13
    v_mul_f32 v16, v16, v13
    v_mul_f32 v16, 0x3d372713, v16
    v_add_f32 v16, v16, v13
    v_mul_f32 v16, 0xc0135761, v16
    v_exp_f32 v16, v16
    s_nop 0
    v_add_f32 v16, 1.0, v16
    v_rcp_f32 v16, v16
    s_nop 0
    v_mul_f32 v13, v13, v16
    v_cvt_pk_bf16_f32 v72, v12, v13
    v_lshlrev_b32 v12, 16, v73
    v_and_b32 v13, 0xffff0000, v73
    v_mul_f32 v16, v12, v12
    v_mul_f32 v16, v16, v12
    v_mul_f32 v16, 0x3d372713, v16
    v_add_f32 v16, v16, v12
    v_mul_f32 v16, 0xc0135761, v16
    v_exp_f32 v16, v16
    s_nop 0
    v_add_f32 v16, 1.0, v16
    v_rcp_f32 v16, v16
    s_nop 0
    v_mul_f32 v12, v12, v16
    v_mul_f32 v16, v13, v13
    v_mul_f32 v16, v16, v13
    v_mul_f32 v16, 0x3d372713, v16
    v_add_f32 v16, v16, v13
    v_mul_f32 v16, 0xc0135761, v16
    v_exp_f32 v16, v16
    s_nop 0
    v_add_f32 v16, 1.0, v16
    v_rcp_f32 v16, v16
    s_nop 0
    v_mul_f32 v13, v13, v16
    v_cvt_pk_bf16_f32 v73, v12, v13
    v_lshlrev_b32 v12, 16, v74
    v_and_b32 v13, 0xffff0000, v74
    v_mul_f32 v16, v12, v12
    v_mul_f32 v16, v16, v12
    v_mul_f32 v16, 0x3d372713, v16
    v_add_f32 v16, v16, v12
    v_mul_f32 v16, 0xc0135761, v16
    v_exp_f32 v16, v16
    s_nop 0
    v_add_f32 v16, 1.0, v16
    v_rcp_f32 v16, v16
    s_nop 0
    v_mul_f32 v12, v12, v16
    v_mul_f32 v16, v13, v13
    v_mul_f32 v16, v16, v13
    v_mul_f32 v16, 0x3d372713, v16
    v_add_f32 v16, v16, v13
    v_mul_f32 v16, 0xc0135761, v16
    v_exp_f32 v16, v16
    s_nop 0
    v_add_f32 v16, 1.0, v16
    v_rcp_f32 v16, v16
    s_nop 0
    v_mul_f32 v13, v13, v16
    v_cvt_pk_bf16_f32 v74, v12, v13
    v_lshlrev_b32 v12, 16, v75
    v_and_b32 v13, 0xffff0000, v75
    v_mul_f32 v16, v12, v12
    v_mul_f32 v16, v16, v12
    v_mul_f32 v16, 0x3d372713, v16
    v_add_f32 v16, v16, v12
    v_mul_f32 v16, 0xc0135761, v16
    v_exp_f32 v16, v16
    s_nop 0
    v_add_f32 v16, 1.0, v16
    v_rcp_f32 v16, v16
    s_nop 0
    v_mul_f32 v12, v12, v16
    v_mul_f32 v16, v13, v13
    v_mul_f32 v16, v16, v13
    v_mul_f32 v16, 0x3d372713, v16
    v_add_f32 v16, v16, v13
    v_mul_f32 v16, 0xc0135761, v16
    v_exp_f32 v16, v16
    s_nop 0
    v_add_f32 v16, 1.0, v16
    v_rcp_f32 v16, v16
    s_nop 0
    v_mul_f32 v13, v13, v16
    v_cvt_pk_bf16_f32 v75, v12, v13
    s_mov_b32 s36, 28672
    buffer_store_dwordx4 v[72:75], v10, s[16:19], s36 offen
    s_waitcnt vmcnt(2) lgkmcnt(1)
    v_lshlrev_b32 v12, 16, v84
    v_and_b32 v13, 0xffff0000, v84
    v_mul_f32 v16, v12, v12
    v_mul_f32 v16, v16, v12
    v_mul_f32 v16, 0x3d372713, v16
    v_add_f32 v16, v16, v12
    v_mul_f32 v16, 0xc0135761, v16
    v_exp_f32 v16, v16
    s_nop 0
    v_add_f32 v16, 1.0, v16
    v_rcp_f32 v16, v16
    s_nop 0
    v_mul_f32 v12, v12, v16
    v_mul_f32 v16, v13, v13
    v_mul_f32 v16, v16, v13
    v_mul_f32 v16, 0x3d372713, v16
    v_add_f32 v16, v16, v13
    v_mul_f32 v16, 0xc0135761, v16
    v_exp_f32 v16, v16
    s_nop 0
    v_add_f32 v16, 1.0, v16
    v_rcp_f32 v16, v16
    s_nop 0
    v_mul_f32 v13, v13, v16
    v_cvt_pk_bf16_f32 v84, v12, v13
    v_lshlrev_b32 v12, 16, v85
    v_and_b32 v13, 0xffff0000, v85
    v_mul_f32 v16, v12, v12
    v_mul_f32 v16, v16, v12
    v_mul_f32 v16, 0x3d372713, v16
    v_add_f32 v16, v16, v12
    v_mul_f32 v16, 0xc0135761, v16
    v_exp_f32 v16, v16
    s_nop 0
    v_add_f32 v16, 1.0, v16
    v_rcp_f32 v16, v16
    s_nop 0
    v_mul_f32 v12, v12, v16
    v_mul_f32 v16, v13, v13
    v_mul_f32 v16, v16, v13
    v_mul_f32 v16, 0x3d372713, v16
    v_add_f32 v16, v16, v13
    v_mul_f32 v16, 0xc0135761, v16
    v_exp_f32 v16, v16
    s_nop 0
    v_add_f32 v16, 1.0, v16
    v_rcp_f32 v16, v16
    s_nop 0
    v_mul_f32 v13, v13, v16
    v_cvt_pk_bf16_f32 v85, v12, v13
    v_lshlrev_b32 v12, 16, v86
    v_and_b32 v13, 0xffff0000, v86
    v_mul_f32 v16, v12, v12
    v_mul_f32 v16, v16, v12
    v_mul_f32 v16, 0x3d372713, v16
    v_add_f32 v16, v16, v12
    v_mul_f32 v16, 0xc0135761, v16
    v_exp_f32 v16, v16
    s_nop 0
    v_add_f32 v16, 1.0, v16
    v_rcp_f32 v16, v16
    s_nop 0
    v_mul_f32 v12, v12, v16
    v_mul_f32 v16, v13, v13
    v_mul_f32 v16, v16, v13
    v_mul_f32 v16, 0x3d372713, v16
    v_add_f32 v16, v16, v13
    v_mul_f32 v16, 0xc0135761, v16
    v_exp_f32 v16, v16
    s_nop 0
    v_add_f32 v16, 1.0, v16
    v_rcp_f32 v16, v16
    s_nop 0
    v_mul_f32 v13, v13, v16
    v_cvt_pk_bf16_f32 v86, v12, v13
    v_lshlrev_b32 v12, 16, v87
    v_and_b32 v13, 0xffff0000, v87
    v_mul_f32 v16, v12, v12
    v_mul_f32 v16, v16, v12
    v_mul_f32 v16, 0x3d372713, v16
    v_add_f32 v16, v16, v12
    v_mul_f32 v16, 0xc0135761, v16
    v_exp_f32 v16, v16
    s_nop 0
    v_add_f32 v16, 1.0, v16
    v_rcp_f32 v16, v16
    s_nop 0
    v_mul_f32 v12, v12, v16
    v_mul_f32 v16, v13, v13
    v_mul_f32 v16, v16, v13
    v_mul_f32 v16, 0x3d372713, v16
    v_add_f32 v16, v16, v13
    v_mul_f32 v16, 0xc0135761, v16
    v_exp_f32 v16, v16
    s_nop 0
    v_add_f32 v16, 1.0, v16
    v_rcp_f32 v16, v16
    s_nop 0
    v_mul_f32 v13, v13, v16
    v_cvt_pk_bf16_f32 v87, v12, v13
    s_mov_b32 s36, 57344
    buffer_store_dwordx4 v[84:87], v10, s[16:19], s36 offen
    s_waitcnt vmcnt(3) lgkmcnt(0)
    v_lshlrev_b32 v12, 16, v96
    v_and_b32 v13, 0xffff0000, v96
    v_mul_f32 v16, v12, v12
    v_mul_f32 v16, v16, v12
    v_mul_f32 v16, 0x3d372713, v16
    v_add_f32 v16, v16, v12
    v_mul_f32 v16, 0xc0135761, v16
    v_exp_f32 v16, v16
    s_nop 0
    v_add_f32 v16, 1.0, v16
    v_rcp_f32 v16, v16
    s_nop 0
    v_mul_f32 v12, v12, v16
    v_mul_f32 v16, v13, v13
    v_mul_f32 v16, v16, v13
    v_mul_f32 v16, 0x3d372713, v16
    v_add_f32 v16, v16, v13
    v_mul_f32 v16, 0xc0135761, v16
    v_exp_f32 v16, v16
    s_nop 0
    v_add_f32 v16, 1.0, v16
    v_rcp_f32 v16, v16
    s_nop 0
    v_mul_f32 v13, v13, v16
    v_cvt_pk_bf16_f32 v96, v12, v13
    v_lshlrev_b32 v12, 16, v97
    v_and_b32 v13, 0xffff0000, v97
    v_mul_f32 v16, v12, v12
    v_mul_f32 v16, v16, v12
    v_mul_f32 v16, 0x3d372713, v16
    v_add_f32 v16, v16, v12
    v_mul_f32 v16, 0xc0135761, v16
    v_exp_f32 v16, v16
    s_nop 0
    v_add_f32 v16, 1.0, v16
    v_rcp_f32 v16, v16
    s_nop 0
    v_mul_f32 v12, v12, v16
    v_mul_f32 v16, v13, v13
    v_mul_f32 v16, v16, v13
    v_mul_f32 v16, 0x3d372713, v16
    v_add_f32 v16, v16, v13
    v_mul_f32 v16, 0xc0135761, v16
    v_exp_f32 v16, v16
    s_nop 0
    v_add_f32 v16, 1.0, v16
    v_rcp_f32 v16, v16
    s_nop 0
    v_mul_f32 v13, v13, v16
    v_cvt_pk_bf16_f32 v97, v12, v13
    v_lshlrev_b32 v12, 16, v98
    v_and_b32 v13, 0xffff0000, v98
    v_mul_f32 v16, v12, v12
    v_mul_f32 v16, v16, v12
    v_mul_f32 v16, 0x3d372713, v16
    v_add_f32 v16, v16, v12
    v_mul_f32 v16, 0xc0135761, v16
    v_exp_f32 v16, v16
    s_nop 0
    v_add_f32 v16, 1.0, v16
    v_rcp_f32 v16, v16
    s_nop 0
    v_mul_f32 v12, v12, v16
    v_mul_f32 v16, v13, v13
    v_mul_f32 v16, v16, v13
    v_mul_f32 v16, 0x3d372713, v16
    v_add_f32 v16, v16, v13
    v_mul_f32 v16, 0xc0135761, v16
    v_exp_f32 v16, v16
    s_nop 0
    v_add_f32 v16, 1.0, v16
    v_rcp_f32 v16, v16
    s_nop 0
    v_mul_f32 v13, v13, v16
    v_cvt_pk_bf16_f32 v98, v12, v13
    v_lshlrev_b32 v12, 16, v99
    v_and_b32 v13, 0xffff0000, v99
    v_mul_f32 v16, v12, v12
    v_mul_f32 v16, v16, v12
    v_mul_f32 v16, 0x3d372713, v16
    v_add_f32 v16, v16, v12
    v_mul_f32 v16, 0xc0135761, v16
    v_exp_f32 v16, v16
    s_nop 0
    v_add_f32 v16, 1.0, v16
    v_rcp_f32 v16, v16
    s_nop 0
    v_mul_f32 v12, v12, v16
    v_mul_f32 v16, v13, v13
    v_mul_f32 v16, v16, v13
    v_mul_f32 v16, 0x3d372713, v16
    v_add_f32 v16, v16, v13
    v_mul_f32 v16, 0xc0135761, v16
    v_exp_f32 v16, v16
    s_nop 0
    v_add_f32 v16, 1.0, v16
    v_rcp_f32 v16, v16
    s_nop 0
    v_mul_f32 v13, v13, v16
    v_cvt_pk_bf16_f32 v99, v12, v13
    s_mov_b32 s36, 86016
    buffer_store_dwordx4 v[96:99], v10, s[16:19], s36 offen
    ds_read_b128 v[60:63], v6 offset:4608
    ds_read_b128 v[72:75], v6 offset:5760
    ds_read_b128 v[84:87], v6 offset:6912
    ds_read_b128 v[96:99], v6 offset:8064
    s_waitcnt vmcnt(0) lgkmcnt(3)
    v_lshlrev_b32 v12, 16, v60
    v_and_b32 v13, 0xffff0000, v60
    v_mul_f32 v16, v12, v12
    v_mul_f32 v16, v16, v12
    v_mul_f32 v16, 0x3d372713, v16
    v_add_f32 v16, v16, v12
    v_mul_f32 v16, 0xc0135761, v16
    v_exp_f32 v16, v16
    s_nop 0
    v_add_f32 v16, 1.0, v16
    v_rcp_f32 v16, v16
    s_nop 0
    v_mul_f32 v12, v12, v16
    v_mul_f32 v16, v13, v13
    v_mul_f32 v16, v16, v13
    v_mul_f32 v16, 0x3d372713, v16
    v_add_f32 v16, v16, v13
    v_mul_f32 v16, 0xc0135761, v16
    v_exp_f32 v16, v16
    s_nop 0
    v_add_f32 v16, 1.0, v16
    v_rcp_f32 v16, v16
    s_nop 0
    v_mul_f32 v13, v13, v16
    v_cvt_pk_bf16_f32 v60, v12, v13
    v_lshlrev_b32 v12, 16, v61
    v_and_b32 v13, 0xffff0000, v61
    v_mul_f32 v16, v12, v12
    v_mul_f32 v16, v16, v12
    v_mul_f32 v16, 0x3d372713, v16
    v_add_f32 v16, v16, v12
    v_mul_f32 v16, 0xc0135761, v16
    v_exp_f32 v16, v16
    s_nop 0
    v_add_f32 v16, 1.0, v16
    v_rcp_f32 v16, v16
    s_nop 0
    v_mul_f32 v12, v12, v16
    v_mul_f32 v16, v13, v13
    v_mul_f32 v16, v16, v13
    v_mul_f32 v16, 0x3d372713, v16
    v_add_f32 v16, v16, v13
    v_mul_f32 v16, 0xc0135761, v16
    v_exp_f32 v16, v16
    s_nop 0
    v_add_f32 v16, 1.0, v16
    v_rcp_f32 v16, v16
    s_nop 0
    v_mul_f32 v13, v13, v16
    v_cvt_pk_bf16_f32 v61, v12, v13
    v_lshlrev_b32 v12, 16, v62
    v_and_b32 v13, 0xffff0000, v62
    v_mul_f32 v16, v12, v12
    v_mul_f32 v16, v16, v12
    v_mul_f32 v16, 0x3d372713, v16
    v_add_f32 v16, v16, v12
    v_mul_f32 v16, 0xc0135761, v16
    v_exp_f32 v16, v16
    s_nop 0
    v_add_f32 v16, 1.0, v16
    v_rcp_f32 v16, v16
    s_nop 0
    v_mul_f32 v12, v12, v16
    v_mul_f32 v16, v13, v13
    v_mul_f32 v16, v16, v13
    v_mul_f32 v16, 0x3d372713, v16
    v_add_f32 v16, v16, v13
    v_mul_f32 v16, 0xc0135761, v16
    v_exp_f32 v16, v16
    s_nop 0
    v_add_f32 v16, 1.0, v16
    v_rcp_f32 v16, v16
    s_nop 0
    v_mul_f32 v13, v13, v16
    v_cvt_pk_bf16_f32 v62, v12, v13
    v_lshlrev_b32 v12, 16, v63
    v_and_b32 v13, 0xffff0000, v63
    v_mul_f32 v16, v12, v12
    v_mul_f32 v16, v16, v12
    v_mul_f32 v16, 0x3d372713, v16
    v_add_f32 v16, v16, v12
    v_mul_f32 v16, 0xc0135761, v16
    v_exp_f32 v16, v16
    s_nop 0
    v_add_f32 v16, 1.0, v16
    v_rcp_f32 v16, v16
    s_nop 0
    v_mul_f32 v12, v12, v16
    v_mul_f32 v16, v13, v13
    v_mul_f32 v16, v16, v13
    v_mul_f32 v16, 0x3d372713, v16
    v_add_f32 v16, v16, v13
    v_mul_f32 v16, 0xc0135761, v16
    v_exp_f32 v16, v16
    s_nop 0
    v_add_f32 v16, 1.0, v16
    v_rcp_f32 v16, v16
    s_nop 0
    v_mul_f32 v13, v13, v16
    v_cvt_pk_bf16_f32 v63, v12, v13
    s_mov_b32 s36, 114688
    buffer_store_dwordx4 v[60:63], v10, s[16:19], s36 offen
    s_waitcnt vmcnt(1) lgkmcnt(2)
    v_lshlrev_b32 v12, 16, v72
    v_and_b32 v13, 0xffff0000, v72
    v_mul_f32 v16, v12, v12
    v_mul_f32 v16, v16, v12
    v_mul_f32 v16, 0x3d372713, v16
    v_add_f32 v16, v16, v12
    v_mul_f32 v16, 0xc0135761, v16
    v_exp_f32 v16, v16
    s_nop 0
    v_add_f32 v16, 1.0, v16
    v_rcp_f32 v16, v16
    s_nop 0
    v_mul_f32 v12, v12, v16
    v_mul_f32 v16, v13, v13
    v_mul_f32 v16, v16, v13
    v_mul_f32 v16, 0x3d372713, v16
    v_add_f32 v16, v16, v13
    v_mul_f32 v16, 0xc0135761, v16
    v_exp_f32 v16, v16
    s_nop 0
    v_add_f32 v16, 1.0, v16
    v_rcp_f32 v16, v16
    s_nop 0
    v_mul_f32 v13, v13, v16
    v_cvt_pk_bf16_f32 v72, v12, v13
    v_lshlrev_b32 v12, 16, v73
    v_and_b32 v13, 0xffff0000, v73
    v_mul_f32 v16, v12, v12
    v_mul_f32 v16, v16, v12
    v_mul_f32 v16, 0x3d372713, v16
    v_add_f32 v16, v16, v12
    v_mul_f32 v16, 0xc0135761, v16
    v_exp_f32 v16, v16
    s_nop 0
    v_add_f32 v16, 1.0, v16
    v_rcp_f32 v16, v16
    s_nop 0
    v_mul_f32 v12, v12, v16
    v_mul_f32 v16, v13, v13
    v_mul_f32 v16, v16, v13
    v_mul_f32 v16, 0x3d372713, v16
    v_add_f32 v16, v16, v13
    v_mul_f32 v16, 0xc0135761, v16
    v_exp_f32 v16, v16
    s_nop 0
    v_add_f32 v16, 1.0, v16
    v_rcp_f32 v16, v16
    s_nop 0
    v_mul_f32 v13, v13, v16
    v_cvt_pk_bf16_f32 v73, v12, v13
    v_lshlrev_b32 v12, 16, v74
    v_and_b32 v13, 0xffff0000, v74
    v_mul_f32 v16, v12, v12
    v_mul_f32 v16, v16, v12
    v_mul_f32 v16, 0x3d372713, v16
    v_add_f32 v16, v16, v12
    v_mul_f32 v16, 0xc0135761, v16
    v_exp_f32 v16, v16
    s_nop 0
    v_add_f32 v16, 1.0, v16
    v_rcp_f32 v16, v16
    s_nop 0
    v_mul_f32 v12, v12, v16
    v_mul_f32 v16, v13, v13
    v_mul_f32 v16, v16, v13
    v_mul_f32 v16, 0x3d372713, v16
    v_add_f32 v16, v16, v13
    v_mul_f32 v16, 0xc0135761, v16
    v_exp_f32 v16, v16
    s_nop 0
    v_add_f32 v16, 1.0, v16
    v_rcp_f32 v16, v16
    s_nop 0
    v_mul_f32 v13, v13, v16
    v_cvt_pk_bf16_f32 v74, v12, v13
    v_lshlrev_b32 v12, 16, v75
    v_and_b32 v13, 0xffff0000, v75
    v_mul_f32 v16, v12, v12
    v_mul_f32 v16, v16, v12
    v_mul_f32 v16, 0x3d372713, v16
    v_add_f32 v16, v16, v12
    v_mul_f32 v16, 0xc0135761, v16
    v_exp_f32 v16, v16
    s_nop 0
    v_add_f32 v16, 1.0, v16
    v_rcp_f32 v16, v16
    s_nop 0
    v_mul_f32 v12, v12, v16
    v_mul_f32 v16, v13, v13
    v_mul_f32 v16, v16, v13
    v_mul_f32 v16, 0x3d372713, v16
    v_add_f32 v16, v16, v13
    v_mul_f32 v16, 0xc0135761, v16
    v_exp_f32 v16, v16
    s_nop 0
    v_add_f32 v16, 1.0, v16
    v_rcp_f32 v16, v16
    s_nop 0
    v_mul_f32 v13, v13, v16
    v_cvt_pk_bf16_f32 v75, v12, v13
    s_mov_b32 s36, 143360
    buffer_store_dwordx4 v[72:75], v10, s[16:19], s36 offen
    s_waitcnt vmcnt(2) lgkmcnt(1)
    v_lshlrev_b32 v12, 16, v84
    v_and_b32 v13, 0xffff0000, v84
    v_mul_f32 v16, v12, v12
    v_mul_f32 v16, v16, v12
    v_mul_f32 v16, 0x3d372713, v16
    v_add_f32 v16, v16, v12
    v_mul_f32 v16, 0xc0135761, v16
    v_exp_f32 v16, v16
    s_nop 0
    v_add_f32 v16, 1.0, v16
    v_rcp_f32 v16, v16
    s_nop 0
    v_mul_f32 v12, v12, v16
    v_mul_f32 v16, v13, v13
    v_mul_f32 v16, v16, v13
    v_mul_f32 v16, 0x3d372713, v16
    v_add_f32 v16, v16, v13
    v_mul_f32 v16, 0xc0135761, v16
    v_exp_f32 v16, v16
    s_nop 0
    v_add_f32 v16, 1.0, v16
    v_rcp_f32 v16, v16
    s_nop 0
    v_mul_f32 v13, v13, v16
    v_cvt_pk_bf16_f32 v84, v12, v13
    v_lshlrev_b32 v12, 16, v85
    v_and_b32 v13, 0xffff0000, v85
    v_mul_f32 v16, v12, v12
    v_mul_f32 v16, v16, v12
    v_mul_f32 v16, 0x3d372713, v16
    v_add_f32 v16, v16, v12
    v_mul_f32 v16, 0xc0135761, v16
    v_exp_f32 v16, v16
    s_nop 0
    v_add_f32 v16, 1.0, v16
    v_rcp_f32 v16, v16
    s_nop 0
    v_mul_f32 v12, v12, v16
    v_mul_f32 v16, v13, v13
    v_mul_f32 v16, v16, v13
    v_mul_f32 v16, 0x3d372713, v16
    v_add_f32 v16, v16, v13
    v_mul_f32 v16, 0xc0135761, v16
    v_exp_f32 v16, v16
    s_nop 0
    v_add_f32 v16, 1.0, v16
    v_rcp_f32 v16, v16
    s_nop 0
    v_mul_f32 v13, v13, v16
    v_cvt_pk_bf16_f32 v85, v12, v13
    v_lshlrev_b32 v12, 16, v86
    v_and_b32 v13, 0xffff0000, v86
    v_mul_f32 v16, v12, v12
    v_mul_f32 v16, v16, v12
    v_mul_f32 v16, 0x3d372713, v16
    v_add_f32 v16, v16, v12
    v_mul_f32 v16, 0xc0135761, v16
    v_exp_f32 v16, v16
    s_nop 0
    v_add_f32 v16, 1.0, v16
    v_rcp_f32 v16, v16
    s_nop 0
    v_mul_f32 v12, v12, v16
    v_mul_f32 v16, v13, v13
    v_mul_f32 v16, v16, v13
    v_mul_f32 v16, 0x3d372713, v16
    v_add_f32 v16, v16, v13
    v_mul_f32 v16, 0xc0135761, v16
    v_exp_f32 v16, v16
    s_nop 0
    v_add_f32 v16, 1.0, v16
    v_rcp_f32 v16, v16
    s_nop 0
    v_mul_f32 v13, v13, v16
    v_cvt_pk_bf16_f32 v86, v12, v13
    v_lshlrev_b32 v12, 16, v87
    v_and_b32 v13, 0xffff0000, v87
    v_mul_f32 v16, v12, v12
    v_mul_f32 v16, v16, v12
    v_mul_f32 v16, 0x3d372713, v16
    v_add_f32 v16, v16, v12
    v_mul_f32 v16, 0xc0135761, v16
    v_exp_f32 v16, v16
    s_nop 0
    v_add_f32 v16, 1.0, v16
    v_rcp_f32 v16, v16
    s_nop 0
    v_mul_f32 v12, v12, v16
    v_mul_f32 v16, v13, v13
    v_mul_f32 v16, v16, v13
    v_mul_f32 v16, 0x3d372713, v16
    v_add_f32 v16, v16, v13
    v_mul_f32 v16, 0xc0135761, v16
    v_exp_f32 v16, v16
    s_nop 0
    v_add_f32 v16, 1.0, v16
    v_rcp_f32 v16, v16
    s_nop 0
    v_mul_f32 v13, v13, v16
    v_cvt_pk_bf16_f32 v87, v12, v13
    s_mov_b32 s36, 172032
    buffer_store_dwordx4 v[84:87], v10, s[16:19], s36 offen
    s_waitcnt vmcnt(3) lgkmcnt(0)
    v_lshlrev_b32 v12, 16, v96
    v_and_b32 v13, 0xffff0000, v96
    v_mul_f32 v16, v12, v12
    v_mul_f32 v16, v16, v12
    v_mul_f32 v16, 0x3d372713, v16
    v_add_f32 v16, v16, v12
    v_mul_f32 v16, 0xc0135761, v16
    v_exp_f32 v16, v16
    s_nop 0
    v_add_f32 v16, 1.0, v16
    v_rcp_f32 v16, v16
    s_nop 0
    v_mul_f32 v12, v12, v16
    v_mul_f32 v16, v13, v13
    v_mul_f32 v16, v16, v13
    v_mul_f32 v16, 0x3d372713, v16
    v_add_f32 v16, v16, v13
    v_mul_f32 v16, 0xc0135761, v16
    v_exp_f32 v16, v16
    s_nop 0
    v_add_f32 v16, 1.0, v16
    v_rcp_f32 v16, v16
    s_nop 0
    v_mul_f32 v13, v13, v16
    v_cvt_pk_bf16_f32 v96, v12, v13
    v_lshlrev_b32 v12, 16, v97
    v_and_b32 v13, 0xffff0000, v97
    v_mul_f32 v16, v12, v12
    v_mul_f32 v16, v16, v12
    v_mul_f32 v16, 0x3d372713, v16
    v_add_f32 v16, v16, v12
    v_mul_f32 v16, 0xc0135761, v16
    v_exp_f32 v16, v16
    s_nop 0
    v_add_f32 v16, 1.0, v16
    v_rcp_f32 v16, v16
    s_nop 0
    v_mul_f32 v12, v12, v16
    v_mul_f32 v16, v13, v13
    v_mul_f32 v16, v16, v13
    v_mul_f32 v16, 0x3d372713, v16
    v_add_f32 v16, v16, v13
    v_mul_f32 v16, 0xc0135761, v16
    v_exp_f32 v16, v16
    s_nop 0
    v_add_f32 v16, 1.0, v16
    v_rcp_f32 v16, v16
    s_nop 0
    v_mul_f32 v13, v13, v16
    v_cvt_pk_bf16_f32 v97, v12, v13
    v_lshlrev_b32 v12, 16, v98
    v_and_b32 v13, 0xffff0000, v98
    v_mul_f32 v16, v12, v12
    v_mul_f32 v16, v16, v12
    v_mul_f32 v16, 0x3d372713, v16
    v_add_f32 v16, v16, v12
    v_mul_f32 v16, 0xc0135761, v16
    v_exp_f32 v16, v16
    s_nop 0
    v_add_f32 v16, 1.0, v16
    v_rcp_f32 v16, v16
    s_nop 0
    v_mul_f32 v12, v12, v16
    v_mul_f32 v16, v13, v13
    v_mul_f32 v16, v16, v13
    v_mul_f32 v16, 0x3d372713, v16
    v_add_f32 v16, v16, v13
    v_mul_f32 v16, 0xc0135761, v16
    v_exp_f32 v16, v16
    s_nop 0
    v_add_f32 v16, 1.0, v16
    v_rcp_f32 v16, v16
    s_nop 0
    v_mul_f32 v13, v13, v16
    v_cvt_pk_bf16_f32 v98, v12, v13
    v_lshlrev_b32 v12, 16, v99
    v_and_b32 v13, 0xffff0000, v99
    v_mul_f32 v16, v12, v12
    v_mul_f32 v16, v16, v12
    v_mul_f32 v16, 0x3d372713, v16
    v_add_f32 v16, v16, v12
    v_mul_f32 v16, 0xc0135761, v16
    v_exp_f32 v16, v16
    s_nop 0
    v_add_f32 v16, 1.0, v16
    v_rcp_f32 v16, v16
    s_nop 0
    v_mul_f32 v12, v12, v16
    v_mul_f32 v16, v13, v13
    v_mul_f32 v16, v16, v13
    v_mul_f32 v16, 0x3d372713, v16
    v_add_f32 v16, v16, v13
    v_mul_f32 v16, 0xc0135761, v16
    v_exp_f32 v16, v16
    s_nop 0
    v_add_f32 v16, 1.0, v16
    v_rcp_f32 v16, v16
    s_nop 0
    v_mul_f32 v13, v13, v16
    v_cvt_pk_bf16_f32 v99, v12, v13
    s_mov_b32 s36, 200704
    buffer_store_dwordx4 v[96:99], v10, s[16:19], s36 offen
win_done1:
    s_endpgm
.globl ln3_kernel
.p2align 8
.type ln3_kernel,@function
ln3_kernel:
    s_cmp_ge_u32 s2, 512
    s_cbranch_scc1 ln3_done1
    s_load_dwordx2 s[8:9], s[0:1], 112
    s_waitcnt lgkmcnt(0)
    s_add_u32 s12, s8, 54525952
    s_addc_u32 s13, s9, 0
    s_and_b32 s13, s13, 0xffff
    s_mov_b32 s14, 7340032
    s_mov_b32 s15, 0x20000
    s_add_u32 s16, s8, 62914560
    s_addc_u32 s17, s9, 0
    s_and_b32 s17, s17, 0xffff
    s_mov_b32 s18, 3670016
    s_mov_b32 s19, 0x20000
    s_mov_b32 s20, s8
    s_mov_b32 s21, s9
    s_and_b32 s21, s21, 0xffff
    s_mov_b32 s22, 12288
    s_mov_b32 s23, 0x20000
    v_lshrrev_b32 v1, 6, v0
    v_and_b32 v2, 63, v0
    s_lshl_b32 s24, s2, 2
    v_add_u32 v1, s24, v1
    v_mul_u32_u24 v3, 3584, v1
    v_lshlrev_b32 v4, 2, v2
    v_add_u32 v3, v3, v4
    v_mul_u32_u24 v5, 1792, v1
    v_add_u32 v5, v5, v4
    buffer_load_dword v10, v3, s[12:15], 0 offen offset:1792
    buffer_load_dword v11, v3, s[12:15], 0 offen offset:2048
    buffer_load_dword v12, v3, s[12:15], 0 offen offset:2304
    buffer_load_dword v13, v3, s[12:15], 0 offen offset:2560
    buffer_load_dword v14, v3, s[12:15], 0 offen offset:2816
    buffer_load_dword v15, v3, s[12:15], 0 offen offset:3072
    buffer_load_dword v16, v3, s[12:15], 0 offen offset:3328
    v_xor_b32 v50, 1, v2
    v_lshlrev_b32 v50, 2, v50
    v_xor_b32 v51, 2, v2
    v_lshlrev_b32 v51, 2, v51
    v_xor_b32 v52, 4, v2
    v_lshlrev_b32 v52, 2, v52
    v_xor_b32 v53, 8, v2
    v_lshlrev_b32 v53, 2, v53
    v_xor_b32 v54, 16, v2
    v_lshlrev_b32 v54, 2, v54
    v_xor_b32 v55, 32, v2
    v_lshlrev_b32 v55, 2, v55
    s_waitcnt vmcnt(0)
    v_lshlrev_b32 v20, 16, v10
    v_and_b32 v21, 0xffff0000, v10
    v_lshlrev_b32 v22, 16, v11
    v_and_b32 v23, 0xffff0000, v11
    v_lshlrev_b32 v24, 16, v12
    v_and_b32 v25, 0xffff0000, v12
    v_lshlrev_b32 v26, 16, v13
    v_and_b32 v27, 0xffff0000, v13
    v_lshlrev_b32 v28, 16, v14
    v_and_b32 v29, 0xffff0000, v14
    v_lshlrev_b32 v30, 16, v15
    v_and_b32 v31, 0xffff0000, v15
    v_lshlrev_b32 v32, 16, v16
    v_and_b32 v33, 0xffff0000, v16
    v_add_f32 v7, v20, v21
    v_add_f32 v7, v7, v22
    v_add_f32 v7, v7, v23
    v_add_f32 v7, v7, v24
    v_add_f32 v7, v7, v25
    v_add_f32 v7, v7, v26
    v_add_f32 v7, v7, v27
    v_add_f32 v7, v7, v28
    v_add_f32 v7, v7, v29
    v_add_f32 v7, v7, v30
    v_add_f32 v7, v7, v31
    v_add_f32 v7, v7, v32
    v_add_f32 v7, v7, v33
    ds_bpermute_b32 v8, v50, v7
    s_waitcnt lgkmcnt(0)
    v_add_f32 v7, v7, v8
    ds_bpermute_b32 v8, v51, v7
    s_waitcnt lgkmcnt(0)
    v_add_f32 v7, v7, v8
    ds_bpermute_b32 v8, v52, v7
    s_waitcnt lgkmcnt(0)
    v_add_f32 v7, v7, v8
    ds_bpermute_b32 v8, v53, v7
    s_waitcnt lgkmcnt(0)
    v_add_f32 v7, v7, v8
    ds_bpermute_b32 v8, v54, v7
    s_waitcnt lgkmcnt(0)
    v_add_f32 v7, v7, v8
    ds_bpermute_b32 v8, v55, v7
    s_waitcnt lgkmcnt(0)
    v_add_f32 v7, v7, v8
    v_mul_f32 v7, 0.0011160714285714285, v7
    v_sub_f32 v20, v20, v7
    v_sub_f32 v21, v21, v7
    v_sub_f32 v22, v22, v7
    v_sub_f32 v23, v23, v7
    v_sub_f32 v24, v24, v7
    v_sub_f32 v25, v25, v7
    v_sub_f32 v26, v26, v7
    v_sub_f32 v27, v27, v7
    v_sub_f32 v28, v28, v7
    v_sub_f32 v29, v29, v7
    v_sub_f32 v30, v30, v7
    v_sub_f32 v31, v31, v7
    v_sub_f32 v32, v32, v7
    v_sub_f32 v33, v33, v7
    v_mul_f32 v9, v20, v20
    v_fmac_f32 v9, v21, v21
    v_fmac_f32 v9, v22, v22
    v_fmac_f32 v9, v23, v23
    v_fmac_f32 v9, v24, v24
    v_fmac_f32 v9, v25, v25
    v_fmac_f32 v9, v26, v26
    v_fmac_f32 v9, v27, v27
    v_fmac_f32 v9, v28, v28
    v_fmac_f32 v9, v29, v29
    v_fmac_f32 v9, v30, v30
    v_fmac_f32 v9, v31, v31
    v_fmac_f32 v9, v32, v32
    v_fmac_f32 v9, v33, v33
    ds_bpermute_b32 v8, v50, v9
    s_waitcnt lgkmcnt(0)
    v_add_f32 v9, v9, v8
    ds_bpermute_b32 v8, v51, v9
    s_waitcnt lgkmcnt(0)
    v_add_f32 v9, v9, v8
    ds_bpermute_b32 v8, v52, v9
    s_waitcnt lgkmcnt(0)
    v_add_f32 v9, v9, v8
    ds_bpermute_b32 v8, v53, v9
    s_waitcnt lgkmcnt(0)
    v_add_f32 v9, v9, v8
    ds_bpermute_b32 v8, v54, v9
    s_waitcnt lgkmcnt(0)
    v_add_f32 v9, v9, v8
    ds_bpermute_b32 v8, v55, v9
    s_waitcnt lgkmcnt(0)
    v_add_f32 v9, v9, v8
    v_mul_f32 v9, 0.0011160714285714285, v9
    v_add_f32 v9, 0x3727c5ac, v9
    v_rsq_f32 v9, v9
    s_nop 0
    v_mul_f32 v20, v20, v9
    v_mul_f32 v21, v21, v9
    v_cvt_pk_bf16_f32 v20, v20, v21
    buffer_store_dword v20, v5, s[16:19], 0 offen offset:0
    v_mul_f32 v22, v22, v9
    v_mul_f32 v23, v23, v9
    v_cvt_pk_bf16_f32 v22, v22, v23
    buffer_store_dword v22, v5, s[16:19], 0 offen offset:256
    v_mul_f32 v24, v24, v9
    v_mul_f32 v25, v25, v9
    v_cvt_pk_bf16_f32 v24, v24, v25
    buffer_store_dword v24, v5, s[16:19], 0 offen offset:512
    v_mul_f32 v26, v26, v9
    v_mul_f32 v27, v27, v9
    v_cvt_pk_bf16_f32 v26, v26, v27
    buffer_store_dword v26, v5, s[16:19], 0 offen offset:768
    v_mul_f32 v28, v28, v9
    v_mul_f32 v29, v29, v9
    v_cvt_pk_bf16_f32 v28, v28, v29
    buffer_store_dword v28, v5, s[16:19], 0 offen offset:1024
    v_mul_f32 v30, v30, v9
    v_mul_f32 v31, v31, v9
    v_cvt_pk_bf16_f32 v30, v30, v31
    buffer_store_dword v30, v5, s[16:19], 0 offen offset:1280
    v_mul_f32 v32, v32, v9
    v_mul_f32 v33, v33, v9
    v_cvt_pk_bf16_f32 v32, v32, v33
    buffer_store_dword v32, v5, s[16:19], 0 offen offset:1536
ln3_done1:
    s_endpgm
.globl wsp_kernel
.p2align 8
.type wsp_kernel,@function
wsp_kernel:
    s_cmp_ge_u32 s2, 224
    s_cbranch_scc1 wsp_done1
    s_load_dwordx2 s[28:29], s[0:1], 112
    s_load_dwordx2 s[40:41], s[0:1], 56
    s_load_dwordx2 s[42:43], s[0:1], 64
    s_waitcnt lgkmcnt(0)
    s_mov_b32 s8, s40
    s_mov_b32 s9, s41
    s_and_b32 s9, s9, 0xffff
    s_mov_b32 s10, 8388608
    s_mov_b32 s11, 0x20000
    s_add_u32 s12, s28, 62914560
    s_addc_u32 s13, s29, 0
    s_and_b32 s13, s13, 0xffff
    s_mov_b32 s14, 3670016
    s_mov_b32 s15, 0x20000
    s_add_u32 s16, s28, 67108864
    s_addc_u32 s17, s29, 0
    s_and_b32 s17, s17, 0xffff
    s_mov_b32 s18, 3670016
    s_mov_b32 s19, 0x20000
    s_mov_b32 s20, s42
    s_mov_b32 s21, s43
    s_and_b32 s21, s21, 0xffff
    s_mov_b32 s22, 4096
    s_mov_b32 s23, 0x20000
    s_add_u32 s24, s28, 54525952
    s_addc_u32 s25, s29, 0
    s_and_b32 s25, s25, 0xffff
    s_mov_b32 s26, 7340032
    s_mov_b32 s27, 0x20000
    s_and_b32 s39, s2, 0
    s_lshr_b32 s2, s2, 0
    s_mov_b32 s30, 306783379
    s_mul_hi_u32 s31, s2, s30
    s_mul_i32 s32, s31, 14
    s_sub_u32 s32, s2, s32
    s_mul_i32 s33, s31, 128
    s_mul_i32 s34, s32, 64
    v_lshrrev_b32 v1, 6, v0
    v_and_b32 v2, 63, v0
    v_readfirstlane_b32 s35, v1
    s_nop 3
    v_lshrrev_b32 v6, 3, v2
    s_mul_i32 s36, s35, 32
    s_add_u32 s36, s36, s33
    v_add_u32 v6, s36, v6
    v_mul_u32_u24 v6, 4096, v6
    v_lshrrev_b32 v7, 4, v2
    v_and_b32 v8, 7, v2
    v_add_u32 v9, 0, v7
    v_and_b32 v9, 7, v9
    v_xor_b32 v9, v9, v8
    v_lshlrev_b32 v9, 4, v9
    v_add_u32 v3, v6, v9
    v_add_u32 v9, 4, v7
    v_and_b32 v9, 7, v9
    v_xor_b32 v9, v9, v8
    v_lshlrev_b32 v9, 4, v9
    v_add_u32 v4, v6, v9
    v_lshrrev_b32 v6, 3, v2
    v_and_b32 v8, 7, v2
    v_lshrrev_b32 v9, 4, v2
    v_and_b32 v9, 1, v9
    v_lshlrev_b32 v9, 2, v9
    v_xor_b32 v9, v9, v8
    s_mul_i32 s36, s35, 16
    v_add_u32 v6, s36, v6
    v_mul_u32_u24 v6, 1792, v6
    v_lshlrev_b32 v9, 4, v9
    v_add_u32 v6, v6, v9
    s_lshl_b32 s36, s34, 1
    v_add_u32 v5, s36, v6
    s_lshr_b32 s37, s35, 1
    s_and_b32 s38, s35, 1
    v_and_b32 v6, 31, v2
    v_lshrrev_b32 v7, 5, v2
    s_mul_i32 s36, s37, 64
    v_add_u32 v8, s36, v6
    v_lshrrev_b32 v9, 1, v8
    v_and_b32 v9, 7, v9
    v_xor_b32 v9, v9, v7
    v_lshlrev_b32 v9, 4, v9
    v_lshlrev_b32 v8, 7, v8
    v_add_u32 v10, v8, v9
    v_xor_b32 v11, 32, v10
    v_xor_b32 v12, 64, v10
    v_xor_b32 v13, 96, v10
    v_lshrrev_b32 v6, 4, v2
    v_and_b32 v7, 15, v2
    v_lshrrev_b32 v8, 1, v6
    v_lshlrev_b32 v8, 3, v8
    v_lshrrev_b32 v9, 2, v7
    v_add_u32 v8, v8, v9
    v_mul_u32_u24 v8, 128, v8
    v_and_b32 v6, 1, v6
    v_lshlrev_b32 v6, 1, v6
    v_and_b32 v16, 3, v7
    v_lshrrev_b32 v16, 1, v16
    v_add_u32 v6, v6, v16
    s_mul_i32 s36, s38, 4
    v_add_u32 v6, s36, v6
    v_lshrrev_b32 v9, 1, v9
    v_lshlrev_b32 v9, 2, v9
    v_and_b32 v16, 1, v7
    v_lshlrev_b32 v16, 3, v16
    v_add_u32 v8, v8, v16
    v_add_u32 v16, 0, v6
    v_xor_b32 v16, v16, v9
    v_lshlrev_b32 v16, 4, v16
    v_add_u32 v14, v8, v16
    v_add_u32 v14, 16384, v14
    v_add_u32 v20, 0x10000, v10
    v_add_u32 v21, 0x10000, v11
    v_add_u32 v22, 0x10000, v12
    v_add_u32 v23, 0x10000, v13
    v_add_u32 v24, 0x10000, v14
    v_mov_b32 v52, 0
    v_mov_b32 v53, 0
    v_mov_b32 v54, 0
    v_mov_b32 v55, 0
    v_mov_b32 v56, 0
    v_mov_b32 v57, 0
    v_mov_b32 v58, 0
    v_mov_b32 v59, 0
    v_mov_b32 v60, 0
    v_mov_b32 v61, 0
    v_mov_b32 v62, 0
    v_mov_b32 v63, 0
    v_mov_b32 v64, 0
    v_mov_b32 v65, 0
    v_mov_b32 v66, 0
    v_mov_b32 v67, 0
    v_mov_b32 v68, 0
    v_mov_b32 v69, 0
    v_mov_b32 v70, 0
    v_mov_b32 v71, 0
    v_mov_b32 v72, 0
    v_mov_b32 v73, 0
    v_mov_b32 v74, 0
    v_mov_b32 v75, 0
    v_mov_b32 v76, 0
    v_mov_b32 v77, 0
    v_mov_b32 v78, 0
    v_mov_b32 v79, 0
    v_mov_b32 v80, 0
    v_mov_b32 v81, 0
    v_mov_b32 v82, 0
    v_mov_b32 v83, 0
    s_mul_i32 s40, s39, 4096
    s_mul_i32 s41, s39, 3670016
    s_mul_i32 s36, s35, 4096
    s_add_u32 m0, s36, 0
    s_add_u32 s36, s40, 0
    buffer_load_dwordx4 v3, s[8:11], s36 offen lds
    s_mul_i32 s36, s35, 4096
    s_add_u32 m0, s36, 1024
    s_add_u32 s36, s40, 32768
    buffer_load_dwordx4 v4, s[8:11], s36 offen lds
    s_mul_i32 s36, s35, 4096
    s_add_u32 m0, s36, 2048
    s_add_u32 s36, s40, 65536
    buffer_load_dwordx4 v3, s[8:11], s36 offen lds
    s_mul_i32 s36, s35, 4096
    s_add_u32 m0, s36, 3072
    s_add_u32 s36, s40, 98304
    buffer_load_dwordx4 v4, s[8:11], s36 offen lds
    s_mul_i32 s36, s35, 2048
    s_add_u32 m0, s36, 16384
    s_add_u32 s36, s41, 0
    buffer_load_dwordx4 v5, s[12:15], s36 offen lds
    s_mul_i32 s36, s35, 2048
    s_add_u32 m0, s36, 17408
    s_add_u32 s36, s41, 14336
    buffer_load_dwordx4 v5, s[12:15], s36 offen lds
    s_add_u32 s40, s40, 128
    s_add_u32 s41, s41, 114688
    s_mul_i32 s36, s35, 4096
    s_add_u32 m0, s36, 24576
    s_add_u32 s36, s40, 0
    buffer_load_dwordx4 v3, s[8:11], s36 offen lds
    s_mul_i32 s36, s35, 4096
    s_add_u32 m0, s36, 25600
    s_add_u32 s36, s40, 32768
    buffer_load_dwordx4 v4, s[8:11], s36 offen lds
    s_mul_i32 s36, s35, 4096
    s_add_u32 m0, s36, 26624
    s_add_u32 s36, s40, 65536
    buffer_load_dwordx4 v3, s[8:11], s36 offen lds
    s_mul_i32 s36, s35, 4096
    s_add_u32 m0, s36, 27648
    s_add_u32 s36, s40, 98304
    buffer_load_dwordx4 v4, s[8:11], s36 offen lds
    s_mul_i32 s36, s35, 2048
    s_add_u32 m0, s36, 40960
    s_add_u32 s36, s41, 0
    buffer_load_dwordx4 v5, s[12:15], s36 offen lds
    s_mul_i32 s36, s35, 2048
    s_add_u32 m0, s36, 41984
    s_add_u32 s36, s41, 14336
    buffer_load_dwordx4 v5, s[12:15], s36 offen lds
    s_add_u32 s40, s40, 128
    s_add_u32 s41, s41, 114688
    s_mov_b32 s42, 10
wsp_loop2:
    s_waitcnt vmcnt(6)
    s_barrier
    s_mul_i32 s36, s35, 4096
    s_add_u32 m0, s36, 49152
    s_add_u32 s36, s40, 0
    buffer_load_dwordx4 v3, s[8:11], s36 offen lds
    s_mul_i32 s36, s35, 4096
    s_add_u32 m0, s36, 50176
    s_add_u32 s36, s40, 32768
    buffer_load_dwordx4 v4, s[8:11], s36 offen lds
    s_mul_i32 s36, s35, 4096
    s_add_u32 m0, s36, 51200
    s_add_u32 s36, s40, 65536
    buffer_load_dwordx4 v3, s[8:11], s36 offen lds
    s_mul_i32 s36, s35, 4096
    s_add_u32 m0, s36, 52224
    s_add_u32 s36, s40, 98304
    buffer_load_dwordx4 v4, s[8:11], s36 offen lds
    s_mul_i32 s36, s35, 2048
    s_add_u32 m0, s36, 65536
    s_add_u32 s36, s41, 0
    buffer_load_dwordx4 v5, s[12:15], s36 offen lds
    s_mul_i32 s36, s35, 2048
    s_add_u32 m0, s36, 66560
    s_add_u32 s36, s41, 14336
    buffer_load_dwordx4 v5, s[12:15], s36 offen lds
    s_add_u32 s40, s40, 128
    s_add_u32 s41, s41, 114688
    ds_read_b128 v[28:31], v10 offset:0
    ds_read_b128 v[32:35], v10 offset:4096
    ds_read_b64_tr_b16 v[36:37], v14 offset:0
    ds_read_b64_tr_b16 v[38:39], v14 offset:512
    ds_read_b128 v[40:43], v11 offset:0
    ds_read_b128 v[44:47], v11 offset:4096
    ds_read_b64_tr_b16 v[48:49], v14 offset:2048
    ds_read_b64_tr_b16 v[50:51], v14 offset:2560
    s_waitcnt lgkmcnt(4)
    v_mfma_f32_32x32x16_bf16 v[52:67], v[36:39], v[28:31], v[52:67]
    v_mfma_f32_32x32x16_bf16 v[68:83], v[36:39], v[32:35], v[68:83]
    ds_read_b128 v[28:31], v12 offset:0
    ds_read_b128 v[32:35], v12 offset:4096
    ds_read_b64_tr_b16 v[36:37], v14 offset:4096
    ds_read_b64_tr_b16 v[38:39], v14 offset:4608
    s_waitcnt lgkmcnt(4)
    v_mfma_f32_32x32x16_bf16 v[52:67], v[48:51], v[40:43], v[52:67]
    v_mfma_f32_32x32x16_bf16 v[68:83], v[48:51], v[44:47], v[68:83]
    ds_read_b128 v[40:43], v13 offset:0
    ds_read_b128 v[44:47], v13 offset:4096
    ds_read_b64_tr_b16 v[48:49], v14 offset:6144
    ds_read_b64_tr_b16 v[50:51], v14 offset:6656
    s_waitcnt lgkmcnt(4)
    v_mfma_f32_32x32x16_bf16 v[52:67], v[36:39], v[28:31], v[52:67]
    v_mfma_f32_32x32x16_bf16 v[68:83], v[36:39], v[32:35], v[68:83]
    s_waitcnt lgkmcnt(0)
    v_mfma_f32_32x32x16_bf16 v[52:67], v[48:51], v[40:43], v[52:67]
    v_mfma_f32_32x32x16_bf16 v[68:83], v[48:51], v[44:47], v[68:83]
    s_waitcnt vmcnt(6)
    s_barrier
    s_mul_i32 s36, s35, 4096
    s_add_u32 m0, s36, 0
    s_add_u32 s36, s40, 0
    buffer_load_dwordx4 v3, s[8:11], s36 offen lds
    s_mul_i32 s36, s35, 4096
    s_add_u32 m0, s36, 1024
    s_add_u32 s36, s40, 32768
    buffer_load_dwordx4 v4, s[8:11], s36 offen lds
    s_mul_i32 s36, s35, 4096
    s_add_u32 m0, s36, 2048
    s_add_u32 s36, s40, 65536
    buffer_load_dwordx4 v3, s[8:11], s36 offen lds
    s_mul_i32 s36, s35, 4096
    s_add_u32 m0, s36, 3072
    s_add_u32 s36, s40, 98304
    buffer_load_dwordx4 v4, s[8:11], s36 offen lds
    s_mul_i32 s36, s35, 2048
    s_add_u32 m0, s36, 16384
    s_add_u32 s36, s41, 0
    buffer_load_dwordx4 v5, s[12:15], s36 offen lds
    s_mul_i32 s36, s35, 2048
    s_add_u32 m0, s36, 17408
    s_add_u32 s36, s41, 14336
    buffer_load_dwordx4 v5, s[12:15], s36 offen lds
    s_add_u32 s40, s40, 128
    s_add_u32 s41, s41, 114688
    ds_read_b128 v[28:31], v10 offset:24576
    ds_read_b128 v[32:35], v10 offset:28672
    ds_read_b64_tr_b16 v[36:37], v14 offset:24576
    ds_read_b64_tr_b16 v[38:39], v14 offset:25088
    ds_read_b128 v[40:43], v11 offset:24576
    ds_read_b128 v[44:47], v11 offset:28672
    ds_read_b64_tr_b16 v[48:49], v14 offset:26624
    ds_read_b64_tr_b16 v[50:51], v14 offset:27136
    s_waitcnt lgkmcnt(4)
    v_mfma_f32_32x32x16_bf16 v[52:67], v[36:39], v[28:31], v[52:67]
    v_mfma_f32_32x32x16_bf16 v[68:83], v[36:39], v[32:35], v[68:83]
    ds_read_b128 v[28:31], v12 offset:24576
    ds_read_b128 v[32:35], v12 offset:28672
    ds_read_b64_tr_b16 v[36:37], v14 offset:28672
    ds_read_b64_tr_b16 v[38:39], v14 offset:29184
    s_waitcnt lgkmcnt(4)
    v_mfma_f32_32x32x16_bf16 v[52:67], v[48:51], v[40:43], v[52:67]
    v_mfma_f32_32x32x16_bf16 v[68:83], v[48:51], v[44:47], v[68:83]
    ds_read_b128 v[40:43], v13 offset:24576
    ds_read_b128 v[44:47], v13 offset:28672
    ds_read_b64_tr_b16 v[48:49], v14 offset:30720
    ds_read_b64_tr_b16 v[50:51], v14 offset:31232
    s_waitcnt lgkmcnt(4)
    v_mfma_f32_32x32x16_bf16 v[52:67], v[36:39], v[28:31], v[52:67]
    v_mfma_f32_32x32x16_bf16 v[68:83], v[36:39], v[32:35], v[68:83]
    s_waitcnt lgkmcnt(0)
    v_mfma_f32_32x32x16_bf16 v[52:67], v[48:51], v[40:43], v[52:67]
    v_mfma_f32_32x32x16_bf16 v[68:83], v[48:51], v[44:47], v[68:83]
    s_waitcnt vmcnt(6)
    s_barrier
    s_mul_i32 s36, s35, 4096
    s_add_u32 m0, s36, 24576
    s_add_u32 s36, s40, 0
    buffer_load_dwordx4 v3, s[8:11], s36 offen lds
    s_mul_i32 s36, s35, 4096
    s_add_u32 m0, s36, 25600
    s_add_u32 s36, s40, 32768
    buffer_load_dwordx4 v4, s[8:11], s36 offen lds
    s_mul_i32 s36, s35, 4096
    s_add_u32 m0, s36, 26624
    s_add_u32 s36, s40, 65536
    buffer_load_dwordx4 v3, s[8:11], s36 offen lds
    s_mul_i32 s36, s35, 4096
    s_add_u32 m0, s36, 27648
    s_add_u32 s36, s40, 98304
    buffer_load_dwordx4 v4, s[8:11], s36 offen lds
    s_mul_i32 s36, s35, 2048
    s_add_u32 m0, s36, 40960
    s_add_u32 s36, s41, 0
    buffer_load_dwordx4 v5, s[12:15], s36 offen lds
    s_mul_i32 s36, s35, 2048
    s_add_u32 m0, s36, 41984
    s_add_u32 s36, s41, 14336
    buffer_load_dwordx4 v5, s[12:15], s36 offen lds
    s_add_u32 s40, s40, 128
    s_add_u32 s41, s41, 114688
    ds_read_b128 v[28:31], v10 offset:49152
    ds_read_b128 v[32:35], v10 offset:53248
    ds_read_b64_tr_b16 v[36:37], v14 offset:49152
    ds_read_b64_tr_b16 v[38:39], v14 offset:49664
    ds_read_b128 v[40:43], v11 offset:49152
    ds_read_b128 v[44:47], v11 offset:53248
    ds_read_b64_tr_b16 v[48:49], v14 offset:51200
    ds_read_b64_tr_b16 v[50:51], v14 offset:51712
    s_waitcnt lgkmcnt(4)
    v_mfma_f32_32x32x16_bf16 v[52:67], v[36:39], v[28:31], v[52:67]
    v_mfma_f32_32x32x16_bf16 v[68:83], v[36:39], v[32:35], v[68:83]
    ds_read_b128 v[28:31], v12 offset:49152
    ds_read_b128 v[32:35], v12 offset:53248
    ds_read_b64_tr_b16 v[36:37], v14 offset:53248
    ds_read_b64_tr_b16 v[38:39], v14 offset:53760
    s_waitcnt lgkmcnt(4)
    v_mfma_f32_32x32x16_bf16 v[52:67], v[48:51], v[40:43], v[52:67]
    v_mfma_f32_32x32x16_bf16 v[68:83], v[48:51], v[44:47], v[68:83]
    ds_read_b128 v[40:43], v13 offset:49152
    ds_read_b128 v[44:47], v13 offset:53248
    ds_read_b64_tr_b16 v[48:49], v14 offset:55296
    ds_read_b64_tr_b16 v[50:51], v14 offset:55808
    s_waitcnt lgkmcnt(4)
    v_mfma_f32_32x32x16_bf16 v[52:67], v[36:39], v[28:31], v[52:67]
    v_mfma_f32_32x32x16_bf16 v[68:83], v[36:39], v[32:35], v[68:83]
    s_waitcnt lgkmcnt(0)
    v_mfma_f32_32x32x16_bf16 v[52:67], v[48:51], v[40:43], v[52:67]
    v_mfma_f32_32x32x16_bf16 v[68:83], v[48:51], v[44:47], v[68:83]
    s_sub_u32 s42, s42, 1
    s_cmp_lg_u32 s42, 0
    s_cbranch_scc1 wsp_loop2
    s_waitcnt vmcnt(6)
    s_barrier
    ds_read_b128 v[28:31], v10 offset:0
    ds_read_b128 v[32:35], v10 offset:4096
    ds_read_b64_tr_b16 v[36:37], v14 offset:0
    ds_read_b64_tr_b16 v[38:39], v14 offset:512
    ds_read_b128 v[40:43], v11 offset:0
    ds_read_b128 v[44:47], v11 offset:4096
    ds_read_b64_tr_b16 v[48:49], v14 offset:2048
    ds_read_b64_tr_b16 v[50:51], v14 offset:2560
    s_waitcnt lgkmcnt(4)
    v_mfma_f32_32x32x16_bf16 v[52:67], v[36:39], v[28:31], v[52:67]
    v_mfma_f32_32x32x16_bf16 v[68:83], v[36:39], v[32:35], v[68:83]
    ds_read_b128 v[28:31], v12 offset:0
    ds_read_b128 v[32:35], v12 offset:4096
    ds_read_b64_tr_b16 v[36:37], v14 offset:4096
    ds_read_b64_tr_b16 v[38:39], v14 offset:4608
    s_waitcnt lgkmcnt(4)
    v_mfma_f32_32x32x16_bf16 v[52:67], v[48:51], v[40:43], v[52:67]
    v_mfma_f32_32x32x16_bf16 v[68:83], v[48:51], v[44:47], v[68:83]
    ds_read_b128 v[40:43], v13 offset:0
    ds_read_b128 v[44:47], v13 offset:4096
    ds_read_b64_tr_b16 v[48:49], v14 offset:6144
    ds_read_b64_tr_b16 v[50:51], v14 offset:6656
    s_waitcnt lgkmcnt(4)
    v_mfma_f32_32x32x16_bf16 v[52:67], v[36:39], v[28:31], v[52:67]
    v_mfma_f32_32x32x16_bf16 v[68:83], v[36:39], v[32:35], v[68:83]
    s_waitcnt lgkmcnt(0)
    v_mfma_f32_32x32x16_bf16 v[52:67], v[48:51], v[40:43], v[52:67]
    v_mfma_f32_32x32x16_bf16 v[68:83], v[48:51], v[44:47], v[68:83]
    s_waitcnt vmcnt(0)
    s_barrier
    ds_read_b128 v[28:31], v10 offset:24576
    ds_read_b128 v[32:35], v10 offset:28672
    ds_read_b64_tr_b16 v[36:37], v14 offset:24576
    ds_read_b64_tr_b16 v[38:39], v14 offset:25088
    ds_read_b128 v[40:43], v11 offset:24576
    ds_read_b128 v[44:47], v11 offset:28672
    ds_read_b64_tr_b16 v[48:49], v14 offset:26624
    ds_read_b64_tr_b16 v[50:51], v14 offset:27136
    s_waitcnt lgkmcnt(4)
    v_mfma_f32_32x32x16_bf16 v[52:67], v[36:39], v[28:31], v[52:67]
    v_mfma_f32_32x32x16_bf16 v[68:83], v[36:39], v[32:35], v[68:83]
    ds_read_b128 v[28:31], v12 offset:24576
    ds_read_b128 v[32:35], v12 offset:28672
    ds_read_b64_tr_b16 v[36:37], v14 offset:28672
    ds_read_b64_tr_b16 v[38:39], v14 offset:29184
    s_waitcnt lgkmcnt(4)
    v_mfma_f32_32x32x16_bf16 v[52:67], v[48:51], v[40:43], v[52:67]
    v_mfma_f32_32x32x16_bf16 v[68:83], v[48:51], v[44:47], v[68:83]
    ds_read_b128 v[40:43], v13 offset:24576
    ds_read_b128 v[44:47], v13 offset:28672
    ds_read_b64_tr_b16 v[48:49], v14 offset:30720
    ds_read_b64_tr_b16 v[50:51], v14 offset:31232
    s_waitcnt lgkmcnt(4)
    v_mfma_f32_32x32x16_bf16 v[52:67], v[36:39], v[28:31], v[52:67]
    v_mfma_f32_32x32x16_bf16 v[68:83], v[36:39], v[32:35], v[68:83]
    s_waitcnt lgkmcnt(0)
    v_mfma_f32_32x32x16_bf16 v[52:67], v[48:51], v[40:43], v[52:67]
    v_mfma_f32_32x32x16_bf16 v[68:83], v[48:51], v[44:47], v[68:83]
    s_nop 15
    s_nop 7
    s_barrier
    v_and_b32 v6, 31, v2
    v_mul_u32_u24 v6, 80, v6
    v_lshrrev_b32 v7, 5, v2
    v_lshlrev_b32 v7, 3, v7
    v_add_u32 v6, v6, v7
    s_mul_i32 s36, s35, 5120
    v_add_u32 v6, s36, v6
    v_cvt_pk_bf16_f32 v52, v52, v53
    v_cvt_pk_bf16_f32 v53, v54, v55
    ds_write_b64 v6, v[52:53] offset:0
    v_cvt_pk_bf16_f32 v56, v56, v57
    v_cvt_pk_bf16_f32 v57, v58, v59
    ds_write_b64 v6, v[56:57] offset:16
    v_cvt_pk_bf16_f32 v60, v60, v61
    v_cvt_pk_bf16_f32 v61, v62, v63
    ds_write_b64 v6, v[60:61] offset:32
    v_cvt_pk_bf16_f32 v64, v64, v65
    v_cvt_pk_bf16_f32 v65, v66, v67
    ds_write_b64 v6, v[64:65] offset:48
    v_cvt_pk_bf16_f32 v68, v68, v69
    v_cvt_pk_bf16_f32 v69, v70, v71
    ds_write_b64 v6, v[68:69] offset:2560
    v_cvt_pk_bf16_f32 v72, v72, v73
    v_cvt_pk_bf16_f32 v73, v74, v75
    ds_write_b64 v6, v[72:73] offset:2576
    v_cvt_pk_bf16_f32 v76, v76, v77
    v_cvt_pk_bf16_f32 v77, v78, v79
    ds_write_b64 v6, v[76:77] offset:2592
    v_cvt_pk_bf16_f32 v80, v80, v81
    v_cvt_pk_bf16_f32 v81, v82, v83
    ds_write_b64 v6, v[80:81] offset:2608
    v_lshrrev_b32 v8, 2, v2
    v_and_b32 v9, 3, v2
    v_mul_u32_u24 v6, 80, v8
    v_lshlrev_b32 v7, 4, v9
    v_add_u32 v6, v6, v7
    v_add_u32 v6, s36, v6
    s_mul_i32 s36, s37, 64
    s_add_u32 s36, s36, s33
    v_add_u32 v8, s36, v8
    v_lshlrev_b32 v9, 3, v9
    s_mul_i32 s36, s38, 32
    s_add_u32 s36, s36, s34
    v_add_u32 v9, s36, v9
    v_mul_u32_u24 v10, 1792, v8
    v_lshlrev_b32 v11, 1, v9
    v_add_u32 v10, v10, v11
    v_mul_u32_u24 v11, 3584, v8
    v_lshlrev_b32 v12, 1, v9
    v_add_u32 v11, v11, v12
    v_lshlrev_b32 v17, 1, v8
    ds_read_b128 v[52:55], v6 offset:0
    s_mov_b32 s36, 0
    buffer_load_dwordx4 v[56:59], v11, s[24:27], s36 offen
    s_mov_b32 s36, 0
    buffer_load_ushort v60, v17, s[20:23], s36 offen
    ds_read_b128 v[64:67], v6 offset:1280
    s_mov_b32 s36, 57344
    buffer_load_dwordx4 v[68:71], v11, s[24:27], s36 offen
    s_mov_b32 s36, 32
    buffer_load_ushort v72, v17, s[20:23], s36 offen
    ds_read_b128 v[76:79], v6 offset:2560
    s_mov_b32 s36, 114688
    buffer_load_dwordx4 v[80:83], v11, s[24:27], s36 offen
    s_mov_b32 s36, 64
    buffer_load_ushort v84, v17, s[20:23], s36 offen
    ds_read_b128 v[88:91], v6 offset:3840
    s_mov_b32 s36, 172032
    buffer_load_dwordx4 v[92:95], v11, s[24:27], s36 offen
    s_mov_b32 s36, 96
    buffer_load_ushort v96, v17, s[20:23], s36 offen
    s_waitcnt vmcnt(6) lgkmcnt(3)
    v_lshlrev_b32 v60, 16, v60
    v_lshlrev_b32 v12, 16, v52
    v_and_b32 v13, 0xffff0000, v52
    v_add_f32 v12, v12, v60
    v_add_f32 v13, v13, v60
    v_cvt_pk_bf16_f32 v12, v12, v13
    v_and_b32 v13, 0xffff0000, v12
    v_lshlrev_b32 v12, 16, v12
    v_lshlrev_b32 v14, 16, v56
    v_and_b32 v15, 0xffff0000, v56
    v_mul_f32 v12, v12, v14
    v_mul_f32 v13, v13, v15
    v_cvt_pk_bf16_f32 v52, v12, v13
    v_lshlrev_b32 v12, 16, v53
    v_and_b32 v13, 0xffff0000, v53
    v_add_f32 v12, v12, v60
    v_add_f32 v13, v13, v60
    v_cvt_pk_bf16_f32 v12, v12, v13
    v_and_b32 v13, 0xffff0000, v12
    v_lshlrev_b32 v12, 16, v12
    v_lshlrev_b32 v14, 16, v57
    v_and_b32 v15, 0xffff0000, v57
    v_mul_f32 v12, v12, v14
    v_mul_f32 v13, v13, v15
    v_cvt_pk_bf16_f32 v53, v12, v13
    v_lshlrev_b32 v12, 16, v54
    v_and_b32 v13, 0xffff0000, v54
    v_add_f32 v12, v12, v60
    v_add_f32 v13, v13, v60
    v_cvt_pk_bf16_f32 v12, v12, v13
    v_and_b32 v13, 0xffff0000, v12
    v_lshlrev_b32 v12, 16, v12
    v_lshlrev_b32 v14, 16, v58
    v_and_b32 v15, 0xffff0000, v58
    v_mul_f32 v12, v12, v14
    v_mul_f32 v13, v13, v15
    v_cvt_pk_bf16_f32 v54, v12, v13
    v_lshlrev_b32 v12, 16, v55
    v_and_b32 v13, 0xffff0000, v55
    v_add_f32 v12, v12, v60
    v_add_f32 v13, v13, v60
    v_cvt_pk_bf16_f32 v12, v12, v13
    v_and_b32 v13, 0xffff0000, v12
    v_lshlrev_b32 v12, 16, v12
    v_lshlrev_b32 v14, 16, v59
    v_and_b32 v15, 0xffff0000, v59
    v_mul_f32 v12, v12, v14
    v_mul_f32 v13, v13, v15
    v_cvt_pk_bf16_f32 v55, v12, v13
    s_mov_b32 s36, 0
    buffer_store_dwordx4 v[52:55], v10, s[16:19], s36 offen
    s_waitcnt vmcnt(5) lgkmcnt(2)
    v_lshlrev_b32 v72, 16, v72
    v_lshlrev_b32 v12, 16, v64
    v_and_b32 v13, 0xffff0000, v64
    v_add_f32 v12, v12, v72
    v_add_f32 v13, v13, v72
    v_cvt_pk_bf16_f32 v12, v12, v13
    v_and_b32 v13, 0xffff0000, v12
    v_lshlrev_b32 v12, 16, v12
    v_lshlrev_b32 v14, 16, v68
    v_and_b32 v15, 0xffff0000, v68
    v_mul_f32 v12, v12, v14
    v_mul_f32 v13, v13, v15
    v_cvt_pk_bf16_f32 v64, v12, v13
    v_lshlrev_b32 v12, 16, v65
    v_and_b32 v13, 0xffff0000, v65
    v_add_f32 v12, v12, v72
    v_add_f32 v13, v13, v72
    v_cvt_pk_bf16_f32 v12, v12, v13
    v_and_b32 v13, 0xffff0000, v12
    v_lshlrev_b32 v12, 16, v12
    v_lshlrev_b32 v14, 16, v69
    v_and_b32 v15, 0xffff0000, v69
    v_mul_f32 v12, v12, v14
    v_mul_f32 v13, v13, v15
    v_cvt_pk_bf16_f32 v65, v12, v13
    v_lshlrev_b32 v12, 16, v66
    v_and_b32 v13, 0xffff0000, v66
    v_add_f32 v12, v12, v72
    v_add_f32 v13, v13, v72
    v_cvt_pk_bf16_f32 v12, v12, v13
    v_and_b32 v13, 0xffff0000, v12
    v_lshlrev_b32 v12, 16, v12
    v_lshlrev_b32 v14, 16, v70
    v_and_b32 v15, 0xffff0000, v70
    v_mul_f32 v12, v12, v14
    v_mul_f32 v13, v13, v15
    v_cvt_pk_bf16_f32 v66, v12, v13
    v_lshlrev_b32 v12, 16, v67
    v_and_b32 v13, 0xffff0000, v67
    v_add_f32 v12, v12, v72
    v_add_f32 v13, v13, v72
    v_cvt_pk_bf16_f32 v12, v12, v13
    v_and_b32 v13, 0xffff0000, v12
    v_lshlrev_b32 v12, 16, v12
    v_lshlrev_b32 v14, 16, v71
    v_and_b32 v15, 0xffff0000, v71
    v_mul_f32 v12, v12, v14
    v_mul_f32 v13, v13, v15
    v_cvt_pk_bf16_f32 v67, v12, v13
    s_mov_b32 s36, 28672
    buffer_store_dwordx4 v[64:67], v10, s[16:19], s36 offen
    s_waitcnt vmcnt(4) lgkmcnt(1)
    v_lshlrev_b32 v84, 16, v84
    v_lshlrev_b32 v12, 16, v76
    v_and_b32 v13, 0xffff0000, v76
    v_add_f32 v12, v12, v84
    v_add_f32 v13, v13, v84
    v_cvt_pk_bf16_f32 v12, v12, v13
    v_and_b32 v13, 0xffff0000, v12
    v_lshlrev_b32 v12, 16, v12
    v_lshlrev_b32 v14, 16, v80
    v_and_b32 v15, 0xffff0000, v80
    v_mul_f32 v12, v12, v14
    v_mul_f32 v13, v13, v15
    v_cvt_pk_bf16_f32 v76, v12, v13
    v_lshlrev_b32 v12, 16, v77
    v_and_b32 v13, 0xffff0000, v77
    v_add_f32 v12, v12, v84
    v_add_f32 v13, v13, v84
    v_cvt_pk_bf16_f32 v12, v12, v13
    v_and_b32 v13, 0xffff0000, v12
    v_lshlrev_b32 v12, 16, v12
    v_lshlrev_b32 v14, 16, v81
    v_and_b32 v15, 0xffff0000, v81
    v_mul_f32 v12, v12, v14
    v_mul_f32 v13, v13, v15
    v_cvt_pk_bf16_f32 v77, v12, v13
    v_lshlrev_b32 v12, 16, v78
    v_and_b32 v13, 0xffff0000, v78
    v_add_f32 v12, v12, v84
    v_add_f32 v13, v13, v84
    v_cvt_pk_bf16_f32 v12, v12, v13
    v_and_b32 v13, 0xffff0000, v12
    v_lshlrev_b32 v12, 16, v12
    v_lshlrev_b32 v14, 16, v82
    v_and_b32 v15, 0xffff0000, v82
    v_mul_f32 v12, v12, v14
    v_mul_f32 v13, v13, v15
    v_cvt_pk_bf16_f32 v78, v12, v13
    v_lshlrev_b32 v12, 16, v79
    v_and_b32 v13, 0xffff0000, v79
    v_add_f32 v12, v12, v84
    v_add_f32 v13, v13, v84
    v_cvt_pk_bf16_f32 v12, v12, v13
    v_and_b32 v13, 0xffff0000, v12
    v_lshlrev_b32 v12, 16, v12
    v_lshlrev_b32 v14, 16, v83
    v_and_b32 v15, 0xffff0000, v83
    v_mul_f32 v12, v12, v14
    v_mul_f32 v13, v13, v15
    v_cvt_pk_bf16_f32 v79, v12, v13
    s_mov_b32 s36, 57344
    buffer_store_dwordx4 v[76:79], v10, s[16:19], s36 offen
    s_waitcnt vmcnt(3) lgkmcnt(0)
    v_lshlrev_b32 v96, 16, v96
    v_lshlrev_b32 v12, 16, v88
    v_and_b32 v13, 0xffff0000, v88
    v_add_f32 v12, v12, v96
    v_add_f32 v13, v13, v96
    v_cvt_pk_bf16_f32 v12, v12, v13
    v_and_b32 v13, 0xffff0000, v12
    v_lshlrev_b32 v12, 16, v12
    v_lshlrev_b32 v14, 16, v92
    v_and_b32 v15, 0xffff0000, v92
    v_mul_f32 v12, v12, v14
    v_mul_f32 v13, v13, v15
    v_cvt_pk_bf16_f32 v88, v12, v13
    v_lshlrev_b32 v12, 16, v89
    v_and_b32 v13, 0xffff0000, v89
    v_add_f32 v12, v12, v96
    v_add_f32 v13, v13, v96
    v_cvt_pk_bf16_f32 v12, v12, v13
    v_and_b32 v13, 0xffff0000, v12
    v_lshlrev_b32 v12, 16, v12
    v_lshlrev_b32 v14, 16, v93
    v_and_b32 v15, 0xffff0000, v93
    v_mul_f32 v12, v12, v14
    v_mul_f32 v13, v13, v15
    v_cvt_pk_bf16_f32 v89, v12, v13
    v_lshlrev_b32 v12, 16, v90
    v_and_b32 v13, 0xffff0000, v90
    v_add_f32 v12, v12, v96
    v_add_f32 v13, v13, v96
    v_cvt_pk_bf16_f32 v12, v12, v13
    v_and_b32 v13, 0xffff0000, v12
    v_lshlrev_b32 v12, 16, v12
    v_lshlrev_b32 v14, 16, v94
    v_and_b32 v15, 0xffff0000, v94
    v_mul_f32 v12, v12, v14
    v_mul_f32 v13, v13, v15
    v_cvt_pk_bf16_f32 v90, v12, v13
    v_lshlrev_b32 v12, 16, v91
    v_and_b32 v13, 0xffff0000, v91
    v_add_f32 v12, v12, v96
    v_add_f32 v13, v13, v96
    v_cvt_pk_bf16_f32 v12, v12, v13
    v_and_b32 v13, 0xffff0000, v12
    v_lshlrev_b32 v12, 16, v12
    v_lshlrev_b32 v14, 16, v95
    v_and_b32 v15, 0xffff0000, v95
    v_mul_f32 v12, v12, v14
    v_mul_f32 v13, v13, v15
    v_cvt_pk_bf16_f32 v91, v12, v13
    s_mov_b32 s36, 86016
    buffer_store_dwordx4 v[88:91], v10, s[16:19], s36 offen
wsp_done1:
    s_endpgm
.globl wout_kernel
.p2align 8
.type wout_kernel,@function
wout_kernel:
    s_cmp_ge_u32 s2, 256
    s_cbranch_scc1 wout_done1
    s_load_dwordx2 s[28:29], s[0:1], 112
    s_load_dwordx2 s[40:41], s[0:1], 72
    s_load_dwordx2 s[42:43], s[0:1], 96
    s_waitcnt lgkmcnt(0)
    s_add_u32 s8, s28, 67108864
    s_addc_u32 s9, s29, 0
    s_and_b32 s9, s9, 0xffff
    s_mov_b32 s10, 3670016
    s_mov_b32 s11, 0x20000
    s_mov_b32 s12, s40
    s_mov_b32 s13, s41
    s_and_b32 s13, s13, 0xffff
    s_mov_b32 s14, 917504
    s_mov_b32 s15, 0x20000
    s_mov_b32 s16, s42
    s_mov_b32 s17, s43
    s_and_b32 s17, s17, 0xffff
    s_mov_b32 s18, 2097152
    s_mov_b32 s19, 0x20000
    s_mov_b32 s20, s28
    s_mov_b32 s21, s29
    s_and_b32 s21, s21, 0xffff
    s_mov_b32 s22, 12288
    s_mov_b32 s23, 0x20000
    s_add_u32 s24, s28, 50331648
    s_addc_u32 s25, s29, 0
    s_and_b32 s25, s25, 0xffff
    s_mov_b32 s26, 2097152
    s_mov_b32 s27, 0x20000
    s_and_b32 s39, s2, 0
    s_lshr_b32 s2, s2, 0
    s_mov_b32 s30, 536870913
    s_mul_hi_u32 s31, s2, s30
    s_mul_i32 s32, s31, 8
    s_sub_u32 s32, s2, s32
    s_mul_i32 s33, s31, 64
    s_mul_i32 s34, s32, 64
    v_lshrrev_b32 v1, 6, v0
    v_and_b32 v2, 63, v0
    v_readfirstlane_b32 s35, v1
    s_nop 3
    v_lshrrev_b32 v6, 3, v2
    s_mul_i32 s36, s35, 16
    s_add_u32 s36, s36, s33
    v_add_u32 v6, s36, v6
    v_mul_u32_u24 v6, 1792, v6
    v_lshrrev_b32 v7, 4, v2
    v_and_b32 v8, 7, v2
    v_add_u32 v9, 0, v7
    v_and_b32 v9, 7, v9
    v_xor_b32 v9, v9, v8
    v_lshlrev_b32 v9, 4, v9
    v_add_u32 v3, v6, v9
    v_add_u32 v9, 4, v7
    v_and_b32 v9, 7, v9
    v_xor_b32 v9, v9, v8
    v_lshlrev_b32 v9, 4, v9
    v_add_u32 v4, v6, v9
    v_lshrrev_b32 v6, 3, v2
    v_and_b32 v8, 7, v2
    v_lshrrev_b32 v9, 4, v2
    v_and_b32 v9, 1, v9
    v_lshlrev_b32 v9, 2, v9
    v_xor_b32 v9, v9, v8
    s_mul_i32 s36, s35, 16
    v_add_u32 v6, s36, v6
    v_mul_u32_u24 v6, 1024, v6
    v_lshlrev_b32 v9, 4, v9
    v_add_u32 v6, v6, v9
    s_lshl_b32 s36, s34, 1
    v_add_u32 v5, s36, v6
    s_lshr_b32 s37, s35, 1
    s_and_b32 s38, s35, 1
    v_and_b32 v6, 31, v2
    v_lshrrev_b32 v7, 5, v2
    s_mul_i32 s36, s37, 32
    v_add_u32 v8, s36, v6
    v_lshrrev_b32 v9, 1, v8
    v_and_b32 v9, 7, v9
    v_xor_b32 v9, v9, v7
    v_lshlrev_b32 v9, 4, v9
    v_lshlrev_b32 v8, 7, v8
    v_add_u32 v10, v8, v9
    v_xor_b32 v11, 32, v10
    v_xor_b32 v12, 64, v10
    v_xor_b32 v13, 96, v10
    v_lshrrev_b32 v6, 4, v2
    v_and_b32 v7, 15, v2
    v_lshrrev_b32 v8, 1, v6
    v_lshlrev_b32 v8, 3, v8
    v_lshrrev_b32 v9, 2, v7
    v_add_u32 v8, v8, v9
    v_mul_u32_u24 v8, 128, v8
    v_and_b32 v6, 1, v6
    v_lshlrev_b32 v6, 1, v6
    v_and_b32 v16, 3, v7
    v_lshrrev_b32 v16, 1, v16
    v_add_u32 v6, v6, v16
    s_mul_i32 s36, s38, 4
    v_add_u32 v6, s36, v6
    v_lshrrev_b32 v9, 1, v9
    v_lshlrev_b32 v9, 2, v9
    v_and_b32 v16, 1, v7
    v_lshlrev_b32 v16, 3, v16
    v_add_u32 v8, v8, v16
    v_add_u32 v16, 0, v6
    v_xor_b32 v16, v16, v9
    v_lshlrev_b32 v16, 4, v16
    v_add_u32 v14, v8, v16
    v_add_u32 v14, 8192, v14
    v_add_u32 v20, 0x10000, v10
    v_add_u32 v21, 0x10000, v11
    v_add_u32 v22, 0x10000, v12
    v_add_u32 v23, 0x10000, v13
    v_add_u32 v24, 0x10000, v14
    v_mov_b32 v44, 0
    v_mov_b32 v45, 0
    v_mov_b32 v46, 0
    v_mov_b32 v47, 0
    v_mov_b32 v48, 0
    v_mov_b32 v49, 0
    v_mov_b32 v50, 0
    v_mov_b32 v51, 0
    v_mov_b32 v52, 0
    v_mov_b32 v53, 0
    v_mov_b32 v54, 0
    v_mov_b32 v55, 0
    v_mov_b32 v56, 0
    v_mov_b32 v57, 0
    v_mov_b32 v58, 0
    v_mov_b32 v59, 0
    s_mul_i32 s40, s39, 1792
    s_mul_i32 s41, s39, 917504
    s_mul_i32 s36, s35, 2048
    s_add_u32 m0, s36, 0
    s_add_u32 s36, s40, 0
    buffer_load_dwordx4 v3, s[8:11], s36 offen lds
    s_mul_i32 s36, s35, 2048
    s_add_u32 m0, s36, 1024
    s_add_u32 s36, s40, 14336
    buffer_load_dwordx4 v4, s[8:11], s36 offen lds
    s_mul_i32 s36, s35, 2048
    s_add_u32 m0, s36, 8192
    s_add_u32 s36, s41, 0
    buffer_load_dwordx4 v5, s[12:15], s36 offen lds
    s_mul_i32 s36, s35, 2048
    s_add_u32 m0, s36, 9216
    s_add_u32 s36, s41, 8192
    buffer_load_dwordx4 v5, s[12:15], s36 offen lds
    s_add_u32 s40, s40, 128
    s_add_u32 s41, s41, 65536
    s_mul_i32 s36, s35, 2048
    s_add_u32 m0, s36, 16384
    s_add_u32 s36, s40, 0
    buffer_load_dwordx4 v3, s[8:11], s36 offen lds
    s_mul_i32 s36, s35, 2048
    s_add_u32 m0, s36, 17408
    s_add_u32 s36, s40, 14336
    buffer_load_dwordx4 v4, s[8:11], s36 offen lds
    s_mul_i32 s36, s35, 2048
    s_add_u32 m0, s36, 24576
    s_add_u32 s36, s41, 0
    buffer_load_dwordx4 v5, s[12:15], s36 offen lds
    s_mul_i32 s36, s35, 2048
    s_add_u32 m0, s36, 25600
    s_add_u32 s36, s41, 8192
    buffer_load_dwordx4 v5, s[12:15], s36 offen lds
    s_add_u32 s40, s40, 128
    s_add_u32 s41, s41, 65536
    s_mul_i32 s36, s35, 2048
    s_add_u32 m0, s36, 32768
    s_add_u32 s36, s40, 0
    buffer_load_dwordx4 v3, s[8:11], s36 offen lds
    s_mul_i32 s36, s35, 2048
    s_add_u32 m0, s36, 33792
    s_add_u32 s36, s40, 14336
    buffer_load_dwordx4 v4, s[8:11], s36 offen lds
    s_mul_i32 s36, s35, 2048
    s_add_u32 m0, s36, 40960
    s_add_u32 s36, s41, 0
    buffer_load_dwordx4 v5, s[12:15], s36 offen lds
    s_mul_i32 s36, s35, 2048
    s_add_u32 m0, s36, 41984
    s_add_u32 s36, s41, 8192
    buffer_load_dwordx4 v5, s[12:15], s36 offen lds
    s_add_u32 s40, s40, 128
    s_add_u32 s41, s41, 65536
    s_mul_i32 s36, s35, 2048
    s_add_u32 m0, s36, 49152
    s_add_u32 s36, s40, 0
    buffer_load_dwordx4 v3, s[8:11], s36 offen lds
    s_mul_i32 s36, s35, 2048
    s_add_u32 m0, s36, 50176
    s_add_u32 s36, s40, 14336
    buffer_load_dwordx4 v4, s[8:11], s36 offen lds
    s_mul_i32 s36, s35, 2048
    s_add_u32 m0, s36, 57344
    s_add_u32 s36, s41, 0
    buffer_load_dwordx4 v5, s[12:15], s36 offen lds
    s_mul_i32 s36, s35, 2048
    s_add_u32 m0, s36, 58368
    s_add_u32 s36, s41, 8192
    buffer_load_dwordx4 v5, s[12:15], s36 offen lds
    s_add_u32 s40, s40, 128
    s_add_u32 s41, s41, 65536
    s_mov_b32 s42, 2
wout_loop2:
    s_waitcnt vmcnt(12)
    s_barrier
    s_mul_i32 s36, s35, 2048
    s_add_u32 m0, s36, 65536
    s_add_u32 s36, s40, 0
    buffer_load_dwordx4 v3, s[8:11], s36 offen lds
    s_mul_i32 s36, s35, 2048
    s_add_u32 m0, s36, 66560
    s_add_u32 s36, s40, 14336
    buffer_load_dwordx4 v4, s[8:11], s36 offen lds
    s_mul_i32 s36, s35, 2048
    s_add_u32 m0, s36, 73728
    s_add_u32 s36, s41, 0
    buffer_load_dwordx4 v5, s[12:15], s36 offen lds
    s_mul_i32 s36, s35, 2048
    s_add_u32 m0, s36, 74752
    s_add_u32 s36, s41, 8192
    buffer_load_dwordx4 v5, s[12:15], s36 offen lds
    s_add_u32 s40, s40, 128
    s_add_u32 s41, s41, 65536
    ds_read_b128 v[28:31], v10 offset:0
    ds_read_b64_tr_b16 v[32:33], v14 offset:0
    ds_read_b64_tr_b16 v[34:35], v14 offset:512
    ds_read_b128 v[36:39], v11 offset:0
    ds_read_b64_tr_b16 v[40:41], v14 offset:2048
    ds_read_b64_tr_b16 v[42:43], v14 offset:2560
    s_waitcnt lgkmcnt(3)
    v_mfma_f32_32x32x16_bf16 v[44:59], v[32:35], v[28:31], v[44:59]
    ds_read_b128 v[28:31], v12 offset:0
    ds_read_b64_tr_b16 v[32:33], v14 offset:4096
    ds_read_b64_tr_b16 v[34:35], v14 offset:4608
    s_waitcnt lgkmcnt(3)
    v_mfma_f32_32x32x16_bf16 v[44:59], v[40:43], v[36:39], v[44:59]
    ds_read_b128 v[36:39], v13 offset:0
    ds_read_b64_tr_b16 v[40:41], v14 offset:6144
    ds_read_b64_tr_b16 v[42:43], v14 offset:6656
    s_waitcnt lgkmcnt(3)
    v_mfma_f32_32x32x16_bf16 v[44:59], v[32:35], v[28:31], v[44:59]
    s_waitcnt lgkmcnt(0)
    v_mfma_f32_32x32x16_bf16 v[44:59], v[40:43], v[36:39], v[44:59]
    s_waitcnt vmcnt(12)
    s_barrier
    s_mul_i32 s36, s35, 2048
    s_add_u32 m0, s36, 0
    s_add_u32 s36, s40, 0
    buffer_load_dwordx4 v3, s[8:11], s36 offen lds
    s_mul_i32 s36, s35, 2048
    s_add_u32 m0, s36, 1024
    s_add_u32 s36, s40, 14336
    buffer_load_dwordx4 v4, s[8:11], s36 offen lds
    s_mul_i32 s36, s35, 2048
    s_add_u32 m0, s36, 8192
    s_add_u32 s36, s41, 0
    buffer_load_dwordx4 v5, s[12:15], s36 offen lds
    s_mul_i32 s36, s35, 2048
    s_add_u32 m0, s36, 9216
    s_add_u32 s36, s41, 8192
    buffer_load_dwordx4 v5, s[12:15], s36 offen lds
    s_add_u32 s40, s40, 128
    s_add_u32 s41, s41, 65536
    ds_read_b128 v[28:31], v10 offset:16384
    ds_read_b64_tr_b16 v[32:33], v14 offset:16384
    ds_read_b64_tr_b16 v[34:35], v14 offset:16896
    ds_read_b128 v[36:39], v11 offset:16384
    ds_read_b64_tr_b16 v[40:41], v14 offset:18432
    ds_read_b64_tr_b16 v[42:43], v14 offset:18944
    s_waitcnt lgkmcnt(3)
    v_mfma_f32_32x32x16_bf16 v[44:59], v[32:35], v[28:31], v[44:59]
    ds_read_b128 v[28:31], v12 offset:16384
    ds_read_b64_tr_b16 v[32:33], v14 offset:20480
    ds_read_b64_tr_b16 v[34:35], v14 offset:20992
    s_waitcnt lgkmcnt(3)
    v_mfma_f32_32x32x16_bf16 v[44:59], v[40:43], v[36:39], v[44:59]
    ds_read_b128 v[36:39], v13 offset:16384
    ds_read_b64_tr_b16 v[40:41], v14 offset:22528
    ds_read_b64_tr_b16 v[42:43], v14 offset:23040
    s_waitcnt lgkmcnt(3)
    v_mfma_f32_32x32x16_bf16 v[44:59], v[32:35], v[28:31], v[44:59]
    s_waitcnt lgkmcnt(0)
    v_mfma_f32_32x32x16_bf16 v[44:59], v[40:43], v[36:39], v[44:59]
    s_waitcnt vmcnt(12)
    s_barrier
    s_mul_i32 s36, s35, 2048
    s_add_u32 m0, s36, 16384
    s_add_u32 s36, s40, 0
    buffer_load_dwordx4 v3, s[8:11], s36 offen lds
    s_mul_i32 s36, s35, 2048
    s_add_u32 m0, s36, 17408
    s_add_u32 s36, s40, 14336
    buffer_load_dwordx4 v4, s[8:11], s36 offen lds
    s_mul_i32 s36, s35, 2048
    s_add_u32 m0, s36, 24576
    s_add_u32 s36, s41, 0
    buffer_load_dwordx4 v5, s[12:15], s36 offen lds
    s_mul_i32 s36, s35, 2048
    s_add_u32 m0, s36, 25600
    s_add_u32 s36, s41, 8192
    buffer_load_dwordx4 v5, s[12:15], s36 offen lds
    s_add_u32 s40, s40, 128
    s_add_u32 s41, s41, 65536
    ds_read_b128 v[28:31], v10 offset:32768
    ds_read_b64_tr_b16 v[32:33], v14 offset:32768
    ds_read_b64_tr_b16 v[34:35], v14 offset:33280
    ds_read_b128 v[36:39], v11 offset:32768
    ds_read_b64_tr_b16 v[40:41], v14 offset:34816
    ds_read_b64_tr_b16 v[42:43], v14 offset:35328
    s_waitcnt lgkmcnt(3)
    v_mfma_f32_32x32x16_bf16 v[44:59], v[32:35], v[28:31], v[44:59]
    ds_read_b128 v[28:31], v12 offset:32768
    ds_read_b64_tr_b16 v[32:33], v14 offset:36864
    ds_read_b64_tr_b16 v[34:35], v14 offset:37376
    s_waitcnt lgkmcnt(3)
    v_mfma_f32_32x32x16_bf16 v[44:59], v[40:43], v[36:39], v[44:59]
    ds_read_b128 v[36:39], v13 offset:32768
    ds_read_b64_tr_b16 v[40:41], v14 offset:38912
    ds_read_b64_tr_b16 v[42:43], v14 offset:39424
    s_waitcnt lgkmcnt(3)
    v_mfma_f32_32x32x16_bf16 v[44:59], v[32:35], v[28:31], v[44:59]
    s_waitcnt lgkmcnt(0)
    v_mfma_f32_32x32x16_bf16 v[44:59], v[40:43], v[36:39], v[44:59]
    s_waitcnt vmcnt(12)
    s_barrier
    s_mul_i32 s36, s35, 2048
    s_add_u32 m0, s36, 32768
    s_add_u32 s36, s40, 0
    buffer_load_dwordx4 v3, s[8:11], s36 offen lds
    s_mul_i32 s36, s35, 2048
    s_add_u32 m0, s36, 33792
    s_add_u32 s36, s40, 14336
    buffer_load_dwordx4 v4, s[8:11], s36 offen lds
    s_mul_i32 s36, s35, 2048
    s_add_u32 m0, s36, 40960
    s_add_u32 s36, s41, 0
    buffer_load_dwordx4 v5, s[12:15], s36 offen lds
    s_mul_i32 s36, s35, 2048
    s_add_u32 m0, s36, 41984
    s_add_u32 s36, s41, 8192
    buffer_load_dwordx4 v5, s[12:15], s36 offen lds
    s_add_u32 s40, s40, 128
    s_add_u32 s41, s41, 65536
    ds_read_b128 v[28:31], v10 offset:49152
    ds_read_b64_tr_b16 v[32:33], v14 offset:49152
    ds_read_b64_tr_b16 v[34:35], v14 offset:49664
    ds_read_b128 v[36:39], v11 offset:49152
    ds_read_b64_tr_b16 v[40:41], v14 offset:51200
    ds_read_b64_tr_b16 v[42:43], v14 offset:51712
    s_waitcnt lgkmcnt(3)
    v_mfma_f32_32x32x16_bf16 v[44:59], v[32:35], v[28:31], v[44:59]
    ds_read_b128 v[28:31], v12 offset:49152
    ds_read_b64_tr_b16 v[32:33], v14 offset:53248
    ds_read_b64_tr_b16 v[34:35], v14 offset:53760
    s_waitcnt lgkmcnt(3)
    v_mfma_f32_32x32x16_bf16 v[44:59], v[40:43], v[36:39], v[44:59]
    ds_read_b128 v[36:39], v13 offset:49152
    ds_read_b64_tr_b16 v[40:41], v14 offset:55296
    ds_read_b64_tr_b16 v[42:43], v14 offset:55808
    s_waitcnt lgkmcnt(3)
    v_mfma_f32_32x32x16_bf16 v[44:59], v[32:35], v[28:31], v[44:59]
    s_waitcnt lgkmcnt(0)
    v_mfma_f32_32x32x16_bf16 v[44:59], v[40:43], v[36:39], v[44:59]
    s_waitcnt vmcnt(12)
    s_barrier
    s_mul_i32 s36, s35, 2048
    s_add_u32 m0, s36, 49152
    s_add_u32 s36, s40, 0
    buffer_load_dwordx4 v3, s[8:11], s36 offen lds
    s_mul_i32 s36, s35, 2048
    s_add_u32 m0, s36, 50176
    s_add_u32 s36, s40, 14336
    buffer_load_dwordx4 v4, s[8:11], s36 offen lds
    s_mul_i32 s36, s35, 2048
    s_add_u32 m0, s36, 57344
    s_add_u32 s36, s41, 0
    buffer_load_dwordx4 v5, s[12:15], s36 offen lds
    s_mul_i32 s36, s35, 2048
    s_add_u32 m0, s36, 58368
    s_add_u32 s36, s41, 8192
    buffer_load_dwordx4 v5, s[12:15], s36 offen lds
    s_add_u32 s40, s40, 128
    s_add_u32 s41, s41, 65536
    ds_read_b128 v[28:31], v20 offset:0
    ds_read_b64_tr_b16 v[32:33], v24 offset:0
    ds_read_b64_tr_b16 v[34:35], v24 offset:512
    ds_read_b128 v[36:39], v21 offset:0
    ds_read_b64_tr_b16 v[40:41], v24 offset:2048
    ds_read_b64_tr_b16 v[42:43], v24 offset:2560
    s_waitcnt lgkmcnt(3)
    v_mfma_f32_32x32x16_bf16 v[44:59], v[32:35], v[28:31], v[44:59]
    ds_read_b128 v[28:31], v22 offset:0
    ds_read_b64_tr_b16 v[32:33], v24 offset:4096
    ds_read_b64_tr_b16 v[34:35], v24 offset:4608
    s_waitcnt lgkmcnt(3)
    v_mfma_f32_32x32x16_bf16 v[44:59], v[40:43], v[36:39], v[44:59]
    ds_read_b128 v[36:39], v23 offset:0
    ds_read_b64_tr_b16 v[40:41], v24 offset:6144
    ds_read_b64_tr_b16 v[42:43], v24 offset:6656
    s_waitcnt lgkmcnt(3)
    v_mfma_f32_32x32x16_bf16 v[44:59], v[32:35], v[28:31], v[44:59]
    s_waitcnt lgkmcnt(0)
    v_mfma_f32_32x32x16_bf16 v[44:59], v[40:43], v[36:39], v[44:59]
    s_sub_u32 s42, s42, 1
    s_cmp_lg_u32 s42, 0
    s_cbranch_scc1 wout_loop2
    s_waitcnt vmcnt(12)
    s_barrier
    ds_read_b128 v[28:31], v10 offset:0
    ds_read_b64_tr_b16 v[32:33], v14 offset:0
    ds_read_b64_tr_b16 v[34:35], v14 offset:512
    ds_read_b128 v[36:39], v11 offset:0
    ds_read_b64_tr_b16 v[40:41], v14 offset:2048
    ds_read_b64_tr_b16 v[42:43], v14 offset:2560
    s_waitcnt lgkmcnt(3)
    v_mfma_f32_32x32x16_bf16 v[44:59], v[32:35], v[28:31], v[44:59]
    ds_read_b128 v[28:31], v12 offset:0
    ds_read_b64_tr_b16 v[32:33], v14 offset:4096
    ds_read_b64_tr_b16 v[34:35], v14 offset:4608
    s_waitcnt lgkmcnt(3)
    v_mfma_f32_32x32x16_bf16 v[44:59], v[40:43], v[36:39], v[44:59]
    ds_read_b128 v[36:39], v13 offset:0
    ds_read_b64_tr_b16 v[40:41], v14 offset:6144
    ds_read_b64_tr_b16 v[42:43], v14 offset:6656
    s_waitcnt lgkmcnt(3)
    v_mfma_f32_32x32x16_bf16 v[44:59], v[32:35], v[28:31], v[44:59]
    s_waitcnt lgkmcnt(0)
    v_mfma_f32_32x32x16_bf16 v[44:59], v[40:43], v[36:39], v[44:59]
    s_waitcnt vmcnt(8)
    s_barrier
    ds_read_b128 v[28:31], v10 offset:16384
    ds_read_b64_tr_b16 v[32:33], v14 offset:16384
    ds_read_b64_tr_b16 v[34:35], v14 offset:16896
    ds_read_b128 v[36:39], v11 offset:16384
    ds_read_b64_tr_b16 v[40:41], v14 offset:18432
    ds_read_b64_tr_b16 v[42:43], v14 offset:18944
    s_waitcnt lgkmcnt(3)
    v_mfma_f32_32x32x16_bf16 v[44:59], v[32:35], v[28:31], v[44:59]
    ds_read_b128 v[28:31], v12 offset:16384
    ds_read_b64_tr_b16 v[32:33], v14 offset:20480
    ds_read_b64_tr_b16 v[34:35], v14 offset:20992
    s_waitcnt lgkmcnt(3)
    v_mfma_f32_32x32x16_bf16 v[44:59], v[40:43], v[36:39], v[44:59]
    ds_read_b128 v[36:39], v13 offset:16384
    ds_read_b64_tr_b16 v[40:41], v14 offset:22528
    ds_read_b64_tr_b16 v[42:43], v14 offset:23040
    s_waitcnt lgkmcnt(3)
    v_mfma_f32_32x32x16_bf16 v[44:59], v[32:35], v[28:31], v[44:59]
    s_waitcnt lgkmcnt(0)
    v_mfma_f32_32x32x16_bf16 v[44:59], v[40:43], v[36:39], v[44:59]
    s_waitcnt vmcnt(4)
    s_barrier
    ds_read_b128 v[28:31], v10 offset:32768
    ds_read_b64_tr_b16 v[32:33], v14 offset:32768
    ds_read_b64_tr_b16 v[34:35], v14 offset:33280
    ds_read_b128 v[36:39], v11 offset:32768
    ds_read_b64_tr_b16 v[40:41], v14 offset:34816
    ds_read_b64_tr_b16 v[42:43], v14 offset:35328
    s_waitcnt lgkmcnt(3)
    v_mfma_f32_32x32x16_bf16 v[44:59], v[32:35], v[28:31], v[44:59]
    ds_read_b128 v[28:31], v12 offset:32768
    ds_read_b64_tr_b16 v[32:33], v14 offset:36864
    ds_read_b64_tr_b16 v[34:35], v14 offset:37376
    s_waitcnt lgkmcnt(3)
    v_mfma_f32_32x32x16_bf16 v[44:59], v[40:43], v[36:39], v[44:59]
    ds_read_b128 v[36:39], v13 offset:32768
    ds_read_b64_tr_b16 v[40:41], v14 offset:38912
    ds_read_b64_tr_b16 v[42:43], v14 offset:39424
    s_waitcnt lgkmcnt(3)
    v_mfma_f32_32x32x16_bf16 v[44:59], v[32:35], v[28:31], v[44:59]
    s_waitcnt lgkmcnt(0)
    v_mfma_f32_32x32x16_bf16 v[44:59], v[40:43], v[36:39], v[44:59]
    s_waitcnt vmcnt(0)
    s_barrier
    ds_read_b128 v[28:31], v10 offset:49152
    ds_read_b64_tr_b16 v[32:33], v14 offset:49152
    ds_read_b64_tr_b16 v[34:35], v14 offset:49664
    ds_read_b128 v[36:39], v11 offset:49152
    ds_read_b64_tr_b16 v[40:41], v14 offset:51200
    ds_read_b64_tr_b16 v[42:43], v14 offset:51712
    s_waitcnt lgkmcnt(3)
    v_mfma_f32_32x32x16_bf16 v[44:59], v[32:35], v[28:31], v[44:59]
    ds_read_b128 v[28:31], v12 offset:49152
    ds_read_b64_tr_b16 v[32:33], v14 offset:53248
    ds_read_b64_tr_b16 v[34:35], v14 offset:53760
    s_waitcnt lgkmcnt(3)
    v_mfma_f32_32x32x16_bf16 v[44:59], v[40:43], v[36:39], v[44:59]
    ds_read_b128 v[36:39], v13 offset:49152
    ds_read_b64_tr_b16 v[40:41], v14 offset:55296
    ds_read_b64_tr_b16 v[42:43], v14 offset:55808
    s_waitcnt lgkmcnt(3)
    v_mfma_f32_32x32x16_bf16 v[44:59], v[32:35], v[28:31], v[44:59]
    s_waitcnt lgkmcnt(0)
    v_mfma_f32_32x32x16_bf16 v[44:59], v[40:43], v[36:39], v[44:59]
    s_nop 15
    s_nop 7
    s_barrier
    v_and_b32 v6, 31, v2
    v_mul_u32_u24 v6, 80, v6
    v_lshrrev_b32 v7, 5, v2
    v_lshlrev_b32 v7, 3, v7
    v_add_u32 v6, v6, v7
    s_mul_i32 s36, s35, 2560
    v_add_u32 v6, s36, v6
    v_cvt_pk_bf16_f32 v44, v44, v45
    v_cvt_pk_bf16_f32 v45, v46, v47
    ds_write_b64 v6, v[44:45] offset:0
    v_cvt_pk_bf16_f32 v48, v48, v49
    v_cvt_pk_bf16_f32 v49, v50, v51
    ds_write_b64 v6, v[48:49] offset:16
    v_cvt_pk_bf16_f32 v52, v52, v53
    v_cvt_pk_bf16_f32 v53, v54, v55
    ds_write_b64 v6, v[52:53] offset:32
    v_cvt_pk_bf16_f32 v56, v56, v57
    v_cvt_pk_bf16_f32 v57, v58, v59
    ds_write_b64 v6, v[56:57] offset:48
    v_lshrrev_b32 v8, 2, v2
    v_and_b32 v9, 3, v2
    v_mul_u32_u24 v6, 80, v8
    v_lshlrev_b32 v7, 4, v9
    v_add_u32 v6, v6, v7
    v_add_u32 v6, s36, v6
    s_mul_i32 s36, s37, 32
    s_add_u32 s36, s36, s33
    v_add_u32 v8, s36, v8
    v_lshlrev_b32 v9, 3, v9
    s_mul_i32 s36, s38, 32
    s_add_u32 s36, s36, s34
    v_add_u32 v9, s36, v9
    v_mul_u32_u24 v10, 1024, v8
    v_lshlrev_b32 v11, 1, v9
    v_add_u32 v10, v10, v11
    v_lshlrev_b32 v12, 2, v9
    s_mov_b32 s36, 10240
    buffer_load_dwordx4 v[20:23], v12, s[20:23], s36 offen
    buffer_load_dwordx4 v[24:27], v12, s[20:23], s36 offen offset:16
    v_mul_u32_u24 v11, 1024, v8
    v_lshlrev_b32 v12, 1, v9
    v_add_u32 v11, v11, v12
    s_waitcnt vmcnt(0)
    ds_read_b128 v[44:47], v6 offset:0
    s_mov_b32 s36, 0
    buffer_load_dwordx4 v[48:51], v11, s[24:27], s36 offen
    ds_read_b128 v[56:59], v6 offset:1280
    s_mov_b32 s36, 16384
    buffer_load_dwordx4 v[60:63], v11, s[24:27], s36 offen
    s_waitcnt vmcnt(1) lgkmcnt(1)
    v_lshlrev_b32 v12, 16, v44
    v_and_b32 v13, 0xffff0000, v44
    v_mul_f32 v12, v12, v20
    v_mul_f32 v13, v13, v21
    v_cvt_pk_bf16_f32 v12, v12, v13
    v_and_b32 v13, 0xffff0000, v12
    v_lshlrev_b32 v12, 16, v12
    v_lshlrev_b32 v14, 16, v48
    v_and_b32 v15, 0xffff0000, v48
    v_add_f32 v12, v12, v14
    v_add_f32 v13, v13, v15
    v_cvt_pk_bf16_f32 v44, v12, v13
    v_lshlrev_b32 v12, 16, v45
    v_and_b32 v13, 0xffff0000, v45
    v_mul_f32 v12, v12, v22
    v_mul_f32 v13, v13, v23
    v_cvt_pk_bf16_f32 v12, v12, v13
    v_and_b32 v13, 0xffff0000, v12
    v_lshlrev_b32 v12, 16, v12
    v_lshlrev_b32 v14, 16, v49
    v_and_b32 v15, 0xffff0000, v49
    v_add_f32 v12, v12, v14
    v_add_f32 v13, v13, v15
    v_cvt_pk_bf16_f32 v45, v12, v13
    v_lshlrev_b32 v12, 16, v46
    v_and_b32 v13, 0xffff0000, v46
    v_mul_f32 v12, v12, v24
    v_mul_f32 v13, v13, v25
    v_cvt_pk_bf16_f32 v12, v12, v13
    v_and_b32 v13, 0xffff0000, v12
    v_lshlrev_b32 v12, 16, v12
    v_lshlrev_b32 v14, 16, v50
    v_and_b32 v15, 0xffff0000, v50
    v_add_f32 v12, v12, v14
    v_add_f32 v13, v13, v15
    v_cvt_pk_bf16_f32 v46, v12, v13
    v_lshlrev_b32 v12, 16, v47
    v_and_b32 v13, 0xffff0000, v47
    v_mul_f32 v12, v12, v26
    v_mul_f32 v13, v13, v27
    v_cvt_pk_bf16_f32 v12, v12, v13
    v_and_b32 v13, 0xffff0000, v12
    v_lshlrev_b32 v12, 16, v12
    v_lshlrev_b32 v14, 16, v51
    v_and_b32 v15, 0xffff0000, v51
    v_add_f32 v12, v12, v14
    v_add_f32 v13, v13, v15
    v_cvt_pk_bf16_f32 v47, v12, v13
    s_mov_b32 s36, 0
    buffer_store_dwordx4 v[44:47], v10, s[16:19], s36 offen
    s_waitcnt vmcnt(1) lgkmcnt(0)
    v_lshlrev_b32 v12, 16, v56
    v_and_b32 v13, 0xffff0000, v56
    v_mul_f32 v12, v12, v20
    v_mul_f32 v13, v13, v21
    v_cvt_pk_bf16_f32 v12, v12, v13
    v_and_b32 v13, 0xffff0000, v12
    v_lshlrev_b32 v12, 16, v12
    v_lshlrev_b32 v14, 16, v60
    v_and_b32 v15, 0xffff0000, v60
    v_add_f32 v12, v12, v14
    v_add_f32 v13, v13, v15
    v_cvt_pk_bf16_f32 v56, v12, v13
    v_lshlrev_b32 v12, 16, v57
    v_and_b32 v13, 0xffff0000, v57
    v_mul_f32 v12, v12, v22
    v_mul_f32 v13, v13, v23
    v_cvt_pk_bf16_f32 v12, v12, v13
    v_and_b32 v13, 0xffff0000, v12
    v_lshlrev_b32 v12, 16, v12
    v_lshlrev_b32 v14, 16, v61
    v_and_b32 v15, 0xffff0000, v61
    v_add_f32 v12, v12, v14
    v_add_f32 v13, v13, v15
    v_cvt_pk_bf16_f32 v57, v12, v13
    v_lshlrev_b32 v12, 16, v58
    v_and_b32 v13, 0xffff0000, v58
    v_mul_f32 v12, v12, v24
    v_mul_f32 v13, v13, v25
    v_cvt_pk_bf16_f32 v12, v12, v13
    v_and_b32 v13, 0xffff0000, v12
    v_lshlrev_b32 v12, 16, v12
    v_lshlrev_b32 v14, 16, v62
    v_and_b32 v15, 0xffff0000, v62
    v_add_f32 v12, v12, v14
    v_add_f32 v13, v13, v15
    v_cvt_pk_bf16_f32 v58, v12, v13
    v_lshlrev_b32 v12, 16, v59
    v_and_b32 v13, 0xffff0000, v59
    v_mul_f32 v12, v12, v26
    v_mul_f32 v13, v13, v27
    v_cvt_pk_bf16_f32 v12, v12, v13
    v_and_b32 v13, 0xffff0000, v12
    v_lshlrev_b32 v12, 16, v12
    v_lshlrev_b32 v14, 16, v63
    v_and_b32 v15, 0xffff0000, v63
    v_add_f32 v12, v12, v14
    v_add_f32 v13, v13, v15
    v_cvt_pk_bf16_f32 v59, v12, v13
    s_mov_b32 s36, 16384
    buffer_store_dwordx4 v[56:59], v10, s[16:19], s36 offen
wout_done1:
    s_endpgm
.section .rodata,"a"
.p2align 6
.amdhsa_kernel mod_kernel
  .amdhsa_next_free_vgpr 128
  .amdhsa_next_free_sgpr 40
  .amdhsa_accum_offset 128
  .amdhsa_group_segment_fixed_size 0
  .amdhsa_kernarg_size 120
  .amdhsa_user_sgpr_count 2
  .amdhsa_user_sgpr_kernarg_segment_ptr 1
  .amdhsa_system_sgpr_workgroup_id_x 1
.end_amdhsa_kernel
.p2align 6
.amdhsa_kernel ln1_kernel
  .amdhsa_next_free_vgpr 96
  .amdhsa_next_free_sgpr 40
  .amdhsa_accum_offset 96
  .amdhsa_group_segment_fixed_size 0
  .amdhsa_kernarg_size 120
  .amdhsa_user_sgpr_count 2
  .amdhsa_user_sgpr_kernarg_segment_ptr 1
  .amdhsa_system_sgpr_workgroup_id_x 1
.end_amdhsa_kernel
.p2align 6
.amdhsa_kernel qproj_kernel
  .amdhsa_next_free_vgpr 124
  .amdhsa_next_free_sgpr 64
  .amdhsa_accum_offset 124
  .amdhsa_group_segment_fixed_size 0
  .amdhsa_kernarg_size 120
  .amdhsa_user_sgpr_count 2
  .amdhsa_user_sgpr_kernarg_segment_ptr 1
  .amdhsa_system_sgpr_workgroup_id_x 1
.end_amdhsa_kernel
.p2align 6
.amdhsa_kernel attn_kernel
  .amdhsa_next_free_vgpr 240
  .amdhsa_next_free_sgpr 64
  .amdhsa_accum_offset 240
  .amdhsa_group_segment_fixed_size 0
  .amdhsa_kernarg_size 120
  .amdhsa_user_sgpr_count 2
  .amdhsa_user_sgpr_kernarg_segment_ptr 1
  .amdhsa_system_sgpr_workgroup_id_x 1
.end_amdhsa_kernel
.p2align 6
.amdhsa_kernel wo_kernel
  .amdhsa_next_free_vgpr 124
  .amdhsa_next_free_sgpr 64
  .amdhsa_accum_offset 124
  .amdhsa_group_segment_fixed_size 0
  .amdhsa_kernarg_size 120
  .amdhsa_user_sgpr_count 2
  .amdhsa_user_sgpr_kernarg_segment_ptr 1
  .amdhsa_system_sgpr_workgroup_id_x 1
.end_amdhsa_kernel
.p2align 6
.amdhsa_kernel ln2_kernel
  .amdhsa_next_free_vgpr 160
  .amdhsa_next_free_sgpr 40
  .amdhsa_accum_offset 160
  .amdhsa_group_segment_fixed_size 0
  .amdhsa_kernarg_size 120
  .amdhsa_user_sgpr_count 2
  .amdhsa_user_sgpr_kernarg_segment_ptr 1
  .amdhsa_system_sgpr_workgroup_id_x 1
.end_amdhsa_kernel
.p2align 6
.amdhsa_kernel win_kernel
  .amdhsa_next_free_vgpr 124
  .amdhsa_next_free_sgpr 64
  .amdhsa_accum_offset 124
  .amdhsa_group_segment_fixed_size 0
  .amdhsa_kernarg_size 120
  .amdhsa_user_sgpr_count 2
  .amdhsa_user_sgpr_kernarg_segment_ptr 1
  .amdhsa_system_sgpr_workgroup_id_x 1
.end_amdhsa_kernel
.p2align 6
.amdhsa_kernel ln3_kernel
  .amdhsa_next_free_vgpr 96
  .amdhsa_next_free_sgpr 40
  .amdhsa_accum_offset 96
  .amdhsa_group_segment_fixed_size 0
  .amdhsa_kernarg_size 120
  .amdhsa_user_sgpr_count 2
  .amdhsa_user_sgpr_kernarg_segment_ptr 1
  .amdhsa_system_sgpr_workgroup_id_x 1
.end_amdhsa_kernel
.p2align 6
.amdhsa_kernel wsp_kernel
  .amdhsa_next_free_vgpr 100
  .amdhsa_next_free_sgpr 64
  .amdhsa_accum_offset 100
  .amdhsa_group_segment_fixed_size 0
  .amdhsa_kernarg_size 120
  .amdhsa_user_sgpr_count 2
  .amdhsa_user_sgpr_kernarg_segment_ptr 1
  .amdhsa_system_sgpr_workgroup_id_x 1
.end_amdhsa_kernel
.p2align 6
.amdhsa_kernel wout_kernel
  .amdhsa_next_free_vgpr 92
  .amdhsa_next_free_sgpr 64
  .amdhsa_accum_offset 92
  .amdhsa_group_segment_fixed_size 0
  .amdhsa_kernarg_size 120
  .amdhsa_user_sgpr_count 2
  .amdhsa_user_sgpr_kernarg_segment_ptr 1
  .amdhsa_system_sgpr_workgroup_id_x 1
.end_amdhsa_kernel
```
